```python
import torch

def _softmax(x, axis=-1):
    return torch.softmax(x, dim=axis)
def _gelu(x):
    return torch.nn.functional.gelu(x, approximate="tanh")
def _silu(x):
    return torch.nn.functional.silu(x)
def _sigmoid(x):
    return torch.sigmoid(x)
def _layernorm(x, axis=-1, eps=1e-5):
    m = x.mean(dim=axis, keepdim=True)
    v = x.var(dim=axis, keepdim=True, unbiased=False)
    return (x - m) / torch.sqrt(v + eps)
def _scatter_add(tgt, idx, src, axis=0):
    return tgt.clone().index_add_(axis, idx, src)
def _segment_sum(src, seg, n):
    out = torch.zeros((n,) + src.shape[1:], dtype=src.dtype)
    return out.index_add_(0, seg, src)
def _pad(x, pw):
    flat = tuple(v for pair in reversed(pw) for v in pair)
    return torch.nn.functional.pad(x, flat)

kernel_name = 'interleave_layers__gqa_block_cached__glu_gated_reglu__decode'

def setup_inputs():

    _w = (lambda a: (lambda t: t.to(torch.bfloat16) if t.is_floating_point() else t)(torch.as_tensor(a)))
    def _A_setup():
        B, Sq, D = 4, 1, 512
        Hq, Hkv, Sk, Dh = 32, 8, 8192, 128
        assert Hq % Hkv == 0, (Hq, Hkv)
        return {
            "x": _w((lambda *s: torch.randn(*s, dtype=torch.bfloat16) * 0.05)(B, Sq, D)),
            "k_cache": _w((lambda *s: torch.randn(*s, dtype=torch.bfloat16) * 1.6)(B, Hkv, Sk, Dh)),
            "v_cache": _w((lambda *s: torch.randn(*s, dtype=torch.bfloat16) * 0.8)(B, Hkv, Sk, Dh)),
            "wq": _w((lambda *s: torch.randn(*s, dtype=torch.bfloat16) * 1.6)(D, Hq * Dh) * (D ** -0.5)),
            "wo": _w((lambda *s: torch.randn(*s, dtype=torch.bfloat16) * 0.8)(Hq * Dh, D) * ((Hq * Dh) ** -0.5)),
        }
    _A_in = _A_setup()

    def _B_setup():
        B, S, D, F = 4, 1, 512, 1792
        return {
            "x": _w((lambda *s: torch.randn(*s, dtype=torch.bfloat16) * 0.05)(B, S, D)),
            "W_gate": _w((lambda *s: torch.randn(*s, dtype=torch.bfloat16) * 0.4)(D, F) * (2.0 / D) ** 0.5),
            "W_up": _w((lambda *s: torch.randn(*s, dtype=torch.bfloat16) * 0.4)(D, F) * (2.0 / D) ** 0.5),
            "W_down": _w((lambda *s: torch.randn(*s, dtype=torch.bfloat16) * 0.4)(F, D) * (1.0 / F) ** 0.5),
        }
    _B_in = _B_setup()

    return {
        "A_x": _A_in["x"],
        "A_k_cache": _A_in["k_cache"],
        "A_v_cache": _A_in["v_cache"],
        "A_wq": _A_in["wq"],
        "A_wo": _A_in["wo"],
        "B_x": _B_in["x"],
        "B_W_gate": _B_in["W_gate"],
        "B_W_up": _B_in["W_up"],
        "B_W_down": _B_in["W_down"],
    }

def reference(A_x, A_k_cache, A_v_cache, A_wq, A_wo, B_x, B_W_gate, B_W_up, B_W_down):
    def _A_ref(x, k_cache, v_cache, wq, wo):
        B, Sq, D = x.shape
        Hq, Dh = 32, 128
        Hkv = k_cache.shape[1]
        rep = Hq // Hkv
        q = (lambda x, *d: x.permute(*d))((x @ wq).reshape(B, Sq, Hq, Dh), 0, 2, 1, 3)
        k = (lambda x, n, axis: torch.repeat_interleave(x, n, dim=axis))(k_cache, rep, axis=1)
        v = (lambda x, n, axis: torch.repeat_interleave(x, n, dim=axis))(v_cache, rep, axis=1)
        scores = torch.einsum("bhqd,bhkd->bhqk", q, k) * (Dh ** -0.5)
        p = _softmax(scores, axis=-1)
        o = torch.einsum("bhqk,bhkd->bhqd", p, v)
        return (lambda x, *d: x.permute(*d))(o, 0, 2, 1, 3).reshape(B, Sq, Hq * Dh) @ wo

    def _B_ref(x, W_gate, W_up, W_down):
        gate = torch.einsum("bsd,df->bsf", x, W_gate)
        up = torch.einsum("bsd,df->bsf", x, W_up)
        gate = gate * (lambda x, dt: x.to(dt))(gate > 0, gate.dtype)
        h = gate * up
        return torch.einsum("bsf,fd->bsd", h, W_down)

    x = A_x
    x = x + _A_ref(_layernorm(x, axis=-1), A_k_cache, A_v_cache, A_wq, A_wo)
    x = x + _B_ref(_layernorm(x, axis=-1), B_W_gate, B_W_up, B_W_down)
    x = x + _A_ref(_layernorm(x, axis=-1), A_k_cache, A_v_cache, A_wq, A_wo)
    x = x + _B_ref(_layernorm(x, axis=-1), B_W_gate, B_W_up, B_W_down)
    return x
```

```asm
; @launch grid=(256,1,1) block=(256,1,1) lds=163840
.amdgcn_target "amdgcn-amd-amdhsa--gfx950"
.text
.globl interleave_layers__gqa_block_cached__glu_gated_reglu__decode_kernel
.p2align 8
.type interleave_layers__gqa_block_cached__glu_gated_reglu__decode_kernel,@function
interleave_layers__gqa_block_cached__glu_gated_reglu__decode_kernel:
    s_cmp_ge_u32 s2, 256
    s_cbranch_scc1 L_end
    s_load_dwordx16 s[36:51], s[0:1], 0
    s_load_dwordx8 s[52:59], s[0:1], 64
    v_lshrrev_b32 v1, 6, v0
    v_and_b32 v0, 63, v0
    v_readfirstlane_b32 s3, v1
    s_and_b32 s20, s2, 7
    s_lshr_b32 s21, s2, 3
    s_lshr_b32 s22, s21, 3
    s_and_b32 s23, s21, 7
    s_mul_i32 s24, s20, 90112
    s_add_u32 s24, s24, 2097152
    s_mov_b32 s25, 0
    s_mov_b32 s26, 0
    s_mov_b32 s27, 0
    s_mov_b32 s28, 0xf000f
    s_mov_b32 s29, 0xf000f
    s_mov_b32 s30, 0xf000f0
    s_mov_b32 s31, 0xf000f0
    s_mov_b32 s32, 0xf000f00
    s_mov_b32 s33, 0xf000f00
    s_mov_b32 s34, 0xf000f000
    s_mov_b32 s35, 0xf000f000
    s_mov_b32 s68, 0x55555555
    s_mov_b32 s69, 0x55555555
    s_mov_b32 s70, 0x00550055
    s_mov_b32 s71, 0x00550055
    s_mov_b32 s72, 0x3e0293ee
    s_mov_b32 s73, 0x3b000000
    s_mov_b32 s74, 0x3727c5ac
    s_lshl_b32 s76, s22, 3
    s_add_u32 s76, s76, s20
    s_lshl_b32 s76, s76, 3
    s_add_u32 s76, s76, s23
    s_lshl_b32 s76, s76, 6
    s_add_u32 s76, s76, s3
    s_lshl_b32 s76, s76, 12
    s_lshl_b32 s79, s3, 15
    v_and_b32 v90, 15, v0
    v_lshrrev_b32 v91, 4, v0
    v_lshlrev_b32 v92, 4, v0
    v_xor_b32 v76, v90, v91
    v_lshlrev_b32 v76, 4, v76
    v_lshl_add_u32 v76, v91, 8, v76
    v_xor_b32 v77, 64, v76
    v_xor_b32 v78, 0x80, v76
    v_xor_b32 v79, 0xc0, v76
    v_xor_b32 v72, v90, v91
    v_lshlrev_b32 v72, 4, v72
    v_lshl_add_u32 v72, v90, 8, v72
    v_add_u32 v72, s79, v72
    v_xor_b32 v73, 64, v72
    v_xor_b32 v74, 0x80, v72
    v_xor_b32 v75, 0xc0, v72
    s_waitcnt lgkmcnt(0)
    s_mov_b32 s1, s2
    s_mov_b32 s8, s38
    s_and_b32 s9, s39, 0xffff
    s_mov_b32 s10, 67108864
    s_mov_b32 s11, 0x20000
    s_add_u32 m0, s79, 16384
    s_add_u32 s78, s76, 0
    buffer_load_dwordx4 v76, s[8:11], s78 offen offset:0 nt lds
    buffer_load_dwordx4 v77, s[8:11], s78 offen offset:1024 nt lds
    buffer_load_dwordx4 v78, s[8:11], s78 offen offset:2048 nt lds
    buffer_load_dwordx4 v79, s[8:11], s78 offen offset:3072 nt lds
    s_add_u32 s58, s58, 0x1fffff
    s_addc_u32 s59, s59, 0
    s_and_b32 s58, s58, 0xffe00000
    s_mov_b32 s4, s58
    s_and_b32 s5, s59, 0xffff
    s_mov_b32 s6, 4194304
    s_mov_b32 s7, 0x20000
    v_mov_b32 v40, -1
    v_mov_b32 v41, -1
    v_mov_b32 v42, -1
    v_mov_b32 v43, -1
    s_lshl_b32 s61, s3, 1
    s_add_u32 s61, s61, 0
    s_mul_i32 s60, s1, 5
    s_add_u32 s60, s60, s61
    s_cmp_lt_u32 s61, 5
    s_cselect_b32 s60, s60, -1
    s_cmp_lt_u32 s60, 1168
    s_cselect_b64 exec, -1, 0
    s_lshl_b32 s60, s60, 10
    s_cmp_ge_u32 s60, 0x74000
    s_cselect_b32 s61, 1622016, 0
    s_add_u32 s60, s60, s61
    buffer_store_dwordx4 v[40:43], v92, s[4:7], s60 offen sc1
    s_mov_b64 exec, -1
    s_cmp_eq_u32 s3, 3
    s_cbranch_scc1 L_clr3
    s_lshl_b32 s61, s3, 1
    s_add_u32 s61, s61, 1
    s_mul_i32 s60, s1, 5
    s_add_u32 s60, s60, s61
    s_cmp_lt_u32 s61, 5
    s_cselect_b32 s60, s60, -1
    s_cmp_lt_u32 s60, 1168
    s_cselect_b64 exec, -1, 0
    s_lshl_b32 s60, s60, 10
    s_cmp_ge_u32 s60, 0x74000
    s_cselect_b32 s61, 1622016, 0
    s_add_u32 s60, s60, s61
    buffer_store_dwordx4 v[40:43], v92, s[4:7], s60 offen sc1
    s_mov_b64 exec, -1
    s_branch L_noclear
L_clr3:
    v_lshrrev_b32 v8, 1, v0
    v_lshlrev_b32 v8, 10, v8
    v_and_b32 v9, 1, v0
    v_lshl_add_u32 v8, v9, 6, v8
    s_lshl_b32 s60, s20, 12
    s_lshl_b32 s61, s23, 7
    s_add_u32 s60, s60, s61
    s_xor_b32 s61, s22, 2
    s_lshl_b32 s61, s61, 4
    s_add_u32 s60, s60, s61
    s_add_u32 s60, s60, 2818048
    s_mov_b64 exec, 0xff
    buffer_store_dwordx4 v[40:43], v8, s[4:7], s60 offen sc1
    s_mov_b64 exec, -1
L_noclear:
    s_add_u32 m0, s79, 4096
    s_add_u32 s78, s76, 16384
    buffer_load_dwordx4 v76, s[8:11], s78 offen offset:0 nt lds
    buffer_load_dwordx4 v77, s[8:11], s78 offen offset:1024 nt lds
    buffer_load_dwordx4 v78, s[8:11], s78 offen offset:2048 nt lds
    buffer_load_dwordx4 v79, s[8:11], s78 offen offset:3072 nt lds
    s_add_u32 m0, s79, 20480
    s_add_u32 s78, s76, 32768
    buffer_load_dwordx4 v76, s[8:11], s78 offen offset:0 nt lds
    buffer_load_dwordx4 v77, s[8:11], s78 offen offset:1024 nt lds
    buffer_load_dwordx4 v78, s[8:11], s78 offen offset:2048 nt lds
    buffer_load_dwordx4 v79, s[8:11], s78 offen offset:3072 nt lds
    s_mov_b32 s12, s40
    s_and_b32 s13, s41, 0xffff
    s_mov_b32 s14, 67108864
    s_mov_b32 s15, 0x20000
    s_mov_b32 s80, s36
    s_and_b32 s81, s37, 0xffff
    s_mov_b32 s82, 4096
    s_mov_b32 s83, 0x20000
    s_mov_b32 s84, s42
    s_and_b32 s85, s43, 0xffff
    s_mov_b32 s86, 4194304
    s_mov_b32 s87, 0x20000
    s_mov_b32 s88, s48
    s_and_b32 s89, s49, 0xffff
    s_mov_b32 s90, 1835008
    s_mov_b32 s91, 0x20000
    s_mov_b32 s92, s50
    s_and_b32 s93, s51, 0xffff
    s_mov_b32 s94, 1835008
    s_mov_b32 s95, 0x20000
    s_mov_b32 s96, s44
    s_and_b32 s97, s45, 0xffff
    s_mov_b32 s98, 4194304
    s_mov_b32 s99, 0x20000
    s_mov_b32 s16, s52
    s_and_b32 s17, s53, 0xffff
    s_mov_b32 s18, 1835008
    s_mov_b32 s19, 0x20000
    s_getreg_b32 s0, hwreg(HW_REG_XCC_ID, 0, 4)
    s_mov_b32 s60, s0
    s_mul_i32 s61, s60, s60
    s_lshl_b32 s61, s61, 15
    s_lshl_b32 s60, s60, 6
    s_add_u32 s77, s60, s61
    s_add_u32 s77, s77, 1
    v_lshlrev_b32 v2, 10, v90
    v_lshl_add_u32 v2, v91, 4, v2
    s_lshl_b32 s60, s3, 8
    v_add_u32 v2, s60, v2
    v_mov_b32 v10, 0x3f803f80
    v_mov_b32 v11, 0x3f803f80
    v_mov_b32 v12, 0x3f803f80
    v_mov_b32 v13, 0x3f803f80
    v_mov_b32 v14, 0x3f803f80
    v_mov_b32 v15, 0x3f803f80
    v_mov_b32 v16, 0x3f803f80
    v_mov_b32 v17, 0x3f803f80
    v_mov_b32 v18, 0x3f803f80
    v_mov_b32 v19, 0x3f803f80
    v_mov_b32 v20, 0x3f803f80
    v_mov_b32 v21, 0x3f803f80
    v_mov_b32 v22, 0x3f803f80
    v_mov_b32 v23, 0x3f803f80
    v_mov_b32 v24, 0x3f803f80
    v_mov_b32 v25, 0x3f803f80
    s_mov_b64 exec, s[28:29]
    buffer_load_dwordx4 v[10:13], v2, s[80:83], 0 offen offset:0
    buffer_load_dwordx4 v[14:17], v2, s[80:83], 0 offen offset:64
    buffer_load_dwordx4 v[18:21], v2, s[80:83], 0 offen offset:128
    buffer_load_dwordx4 v[22:25], v2, s[80:83], 0 offen offset:192
    s_mov_b64 exec, -1
    v_lshlrev_b32 v3, 10, v91
    v_lshl_add_u32 v3, v90, 1, v3
    s_lshl_b32 s60, s21, 5
    buffer_load_ushort v1, v3, s[80:83], s60 offen
    v_lshrrev_b32 v4, 1, v0
    v_and_b32 v5, 1, v0
    v_lshlrev_b32 v5, 4, v5
    v_lshl_add_u32 v84, v4, 13, v5
    v_lshl_add_u32 v93, v4, 10, v5
    s_cmp_lt_u32 s21, 28
    s_cselect_b32 s60, 3584, 0
    v_mul_u32_u24 v85, s60, v0
    v_bfe_u32 v88, v0, 1, 3
    v_lshlrev_b32 v88, 8, v88
    v_lshl_add_u32 v88, v91, 5, v88
    v_add_u32 v88, v88, v5
    s_lshl_b32 s61, s21, 5
    s_lshl_b32 s38, s3, 20
    s_lshl_b32 s60, s20, 10
    s_add_u32 s38, s38, s60
    s_xor_b32 s60, s61, 512
    s_add_u32 s38, s38, s60
    s_lshl_b32 s40, s20, 19
    s_lshl_b32 s60, s3, 17
    s_add_u32 s40, s40, s60
    s_xor_b32 s60, s61, 512
    s_add_u32 s40, s40, s60
    s_mul_i32 s41, s20, 229376
    s_xor_b32 s60, s61, 512
    s_add_u32 s41, s41, s60
    s_min_u32 s61, s21, 27
    s_lshl_b32 s61, s61, 4
    s_mul_i32 s39, s20, 448
    s_add_u32 s39, s39, s61
    s_mul_i32 s61, s3, 458752
    s_add_u32 s39, s39, s61
    s_mov_b32 s44, s72
    s_mov_b32 s45, s72
    s_add_u32 s51, s3, s21
    s_and_b32 s51, s51, 3
    v_and_b32 v80, 7, v0
    v_lshlrev_b32 v80, 7, v80
    v_bfe_u32 v81, v0, 2, 1
    v_mul_u32_u24 v81, 3584, v81
    v_and_b32 v82, 3, v0
    v_lshl_add_u32 v81, v82, 7, v81
    s_add_u32 m0, s79, 8192
    s_add_u32 s78, s76, 49152
    buffer_load_dwordx4 v76, s[8:11], s78 offen offset:0 nt lds
    buffer_load_dwordx4 v77, s[8:11], s78 offen offset:1024 nt lds
    buffer_load_dwordx4 v78, s[8:11], s78 offen offset:2048 nt lds
    buffer_load_dwordx4 v79, s[8:11], s78 offen offset:3072 nt lds
    s_add_u32 m0, s79, 0
    s_add_u32 s60, s38, 0
    buffer_load_dwordx4 v84, s[84:87], s60 offen  lds
    s_add_u32 m0, s79, 24576
    s_add_u32 s78, s76, 65536
    buffer_load_dwordx4 v76, s[8:11], s78 offen offset:0 nt lds
    buffer_load_dwordx4 v77, s[8:11], s78 offen offset:1024 nt lds
    buffer_load_dwordx4 v78, s[8:11], s78 offen offset:2048 nt lds
    buffer_load_dwordx4 v79, s[8:11], s78 offen offset:3072 nt lds
    s_waitcnt vmcnt(24)
    ds_read_b128 a[0:3], v72 offset:16384
    ds_read_b128 a[4:7], v73 offset:16384
    ds_read_b128 a[8:11], v74 offset:16384
    ds_read_b128 a[12:15], v75 offset:16384
    s_add_u32 m0, s79, 1024
    s_add_u32 s60, s38, 262144
    buffer_load_dwordx4 v84, s[84:87], s60 offen  lds
    s_add_u32 m0, s79, 28672
    s_add_u32 s78, s76, 81920
    buffer_load_dwordx4 v76, s[8:11], s78 offen offset:0 nt lds
    buffer_load_dwordx4 v77, s[8:11], s78 offen offset:1024 nt lds
    buffer_load_dwordx4 v78, s[8:11], s78 offen offset:2048 nt lds
    buffer_load_dwordx4 v79, s[8:11], s78 offen offset:3072 nt lds
    s_waitcnt vmcnt(23)
    ds_read_b128 a[16:19], v72 offset:4096
    ds_read_b128 a[20:23], v73 offset:4096
    ds_read_b128 a[24:27], v74 offset:4096
    ds_read_b128 a[28:31], v75 offset:4096
    s_add_u32 m0, s79, 2048
    s_add_u32 s60, s38, 524288
    buffer_load_dwordx4 v84, s[84:87], s60 offen  lds
    s_waitcnt lgkmcnt(0)
    s_add_u32 m0, s79, 16384
    s_add_u32 s78, s76, 98304
    buffer_load_dwordx4 v76, s[8:11], s78 offen offset:0 nt lds
    buffer_load_dwordx4 v77, s[8:11], s78 offen offset:1024 nt lds
    buffer_load_dwordx4 v78, s[8:11], s78 offen offset:2048 nt lds
    buffer_load_dwordx4 v79, s[8:11], s78 offen offset:3072 nt lds
    s_waitcnt vmcnt(24)
    ds_read_b128 a[32:35], v72 offset:20480
    ds_read_b128 a[36:39], v73 offset:20480
    ds_read_b128 a[40:43], v74 offset:20480
    ds_read_b128 a[44:47], v75 offset:20480
    s_add_u32 m0, s79, 3072
    s_add_u32 s60, s38, 786432
    buffer_load_dwordx4 v84, s[84:87], s60 offen  lds
    s_waitcnt lgkmcnt(0)
    s_add_u32 m0, s79, 4096
    s_add_u32 s78, s76, 114688
    buffer_load_dwordx4 v76, s[8:11], s78 offen offset:0 nt lds
    buffer_load_dwordx4 v77, s[8:11], s78 offen offset:1024 nt lds
    buffer_load_dwordx4 v78, s[8:11], s78 offen offset:2048 nt lds
    buffer_load_dwordx4 v79, s[8:11], s78 offen offset:3072 nt lds
    s_waitcnt vmcnt(20)
    ds_read_b128 a[48:51], v72 offset:8192
    ds_read_b128 a[52:55], v73 offset:8192
    ds_read_b128 a[56:59], v74 offset:8192
    ds_read_b128 a[60:63], v75 offset:8192
    s_waitcnt lgkmcnt(0)
    s_add_u32 m0, s79, 20480
    s_add_u32 s78, s76, 131072
    buffer_load_dwordx4 v76, s[8:11], s78 offen offset:0 nt lds
    v_lshrrev_b32 v8, 2, v90
    v_lshl_add_u32 v8, v91, 3, v8
    v_lshlrev_b32 v8, 5, v8
    v_and_b32 v9, 3, v90
    v_lshl_add_u32 v8, v9, 3, v8
    v_add_u32 v8, s79, v8
    s_lshl_b32 s60, s3, 10
    s_add_u32 s60, s60, 154624
    v_add_u32 v26, s60, v92
    v_lshlrev_b32 v27, 4, v90
    v_add_u32 v28, 154880, v27
    v_lshl_add_u32 v27, v91, 2, v27
    v_add_u32 v27, 154624, v27
    v_lshlrev_b32 v29, 2, v91
    v_lshl_add_u32 v30, v91, 4, v29
    v_add_u32 v29, 155200, v29
    v_add_u32 v30, 155136, v30
    buffer_load_dwordx4 v77, s[8:11], s78 offen offset:1024 nt lds
    buffer_load_dwordx4 v78, s[8:11], s78 offen offset:2048 nt lds
    s_waitcnt vmcnt(7)
    ds_read_b64_tr_b16 v[96:97], v8 offset:0
    ds_read_b64_tr_b16 v[98:99], v8 offset:128
    ds_read_b64_tr_b16 v[100:101], v8 offset:1024
    ds_read_b64_tr_b16 v[102:103], v8 offset:1152
    ds_read_b64_tr_b16 v[104:105], v8 offset:2048
    ds_read_b64_tr_b16 v[106:107], v8 offset:2176
    ds_read_b64_tr_b16 v[108:109], v8 offset:3072
    ds_read_b64_tr_b16 v[110:111], v8 offset:3200
    buffer_load_dwordx4 v79, s[8:11], s78 offen offset:3072 nt lds
    s_waitcnt lgkmcnt(0)
    v_mfma_f32_16x16x32_bf16 v[32:35], v[10:13], v[96:99], 0
    v_mfma_f32_16x16x32_bf16 v[36:39], v[10:13], v[10:13], 0
    v_mfma_f32_16x16x32_bf16 v[32:35], v[14:17], v[100:103], v[32:35]
    v_mfma_f32_16x16x32_bf16 v[36:39], v[14:17], v[14:17], v[36:39]
    v_mfma_f32_16x16x32_bf16 v[32:35], v[18:21], v[104:107], v[32:35]
    v_mfma_f32_16x16x32_bf16 v[36:39], v[18:21], v[18:21], v[36:39]
    v_mfma_f32_16x16x32_bf16 v[32:35], v[22:25], v[108:111], v[32:35]
    v_mfma_f32_16x16x32_bf16 v[36:39], v[22:25], v[22:25], v[36:39]
    ds_read_b128 a[64:67], v72 offset:24576
    ds_read_b128 a[68:71], v73 offset:24576
    ds_read_b128 a[72:75], v74 offset:24576
    ds_read_b128 a[76:79], v75 offset:24576
    s_cmp_eq_u32 s51, 0
    s_cselect_b64 s[100:101], -1, 0
    s_lshl_b32 s61, s3, 12
    s_add_u32 m0, s61, 131072
    s_add_u32 s60, s39, 0
    s_mov_b64 exec, s[100:101]
    buffer_load_dwordx4 v85, s[88:91], s60 offen  lds
    s_mov_b64 exec, -1
    s_waitcnt lgkmcnt(0)
    s_add_u32 m0, s79, 8192
    s_add_u32 s78, s76, 147456
    buffer_load_dwordx4 v76, s[8:11], s78 offen offset:0 nt lds
    v_permlane32_swap_b32 v32, v36
    v_permlane32_swap_b32 v33, v37
    v_permlane32_swap_b32 v34, v38
    v_permlane32_swap_b32 v35, v39
    ds_write_b128 v26, v[32:35]
    v_lshrrev_b32 v3, 3, v90
    v_lshlrev_b32 v3, 6, v3
    v_lshl_add_u32 v3, v91, 10, v3
    v_and_b32 v9, 7, v90
    v_lshl_add_u32 v3, v9, 1, v3
    s_lshl_b32 s60, s20, 5
    v_mov_b32 v8, s60
    v_mov_b32 v9, s77
    v_lshlrev_b32 v1, 16, v1
    buffer_load_dwordx4 v77, s[8:11], s78 offen offset:1024 nt lds
    buffer_load_dwordx4 v78, s[8:11], s78 offen offset:2048 nt lds
    buffer_load_dwordx4 v79, s[8:11], s78 offen offset:3072 nt lds
    s_waitcnt lgkmcnt(0)
    s_barrier
    ds_read2st64_b32 v[44:45], v29 offset0:0 offset1:4
    ds_read2st64_b32 v[46:47], v29 offset0:8 offset1:12
    ds_read2st64_b32 v[48:49], v30 offset0:0 offset1:4
    ds_read2st64_b32 v[50:51], v30 offset0:8 offset1:12
    ds_read2st64_b32 v[52:53], v28 offset0:0 offset1:4
    ds_read2st64_b32 v[54:55], v28 offset0:8 offset1:12
    ds_read2st64_b32 v[40:41], v27 offset0:0 offset1:4
    ds_read2st64_b32 v[42:43], v27 offset0:8 offset1:12
    ds_read_b128 a[80:83], v72 offset:28672
    ds_read_b128 a[84:87], v73 offset:28672
    ds_read_b128 a[88:91], v74 offset:28672
    ds_read_b128 a[92:95], v75 offset:28672
    s_cmp_eq_u32 s51, 1
    s_cselect_b64 s[100:101], -1, 0
    s_lshl_b32 s61, s3, 12
    s_add_u32 m0, s61, 131072
    s_add_u32 s60, s39, 0
    s_mov_b64 exec, s[100:101]
    buffer_load_dwordx4 v85, s[88:91], s60 offen  lds
    s_mov_b64 exec, -1
    s_add_u32 m0, s79, 12288
    s_add_u32 s60, s40, 0
    buffer_load_dwordx4 v93, s[96:99], s60 offen  lds
    s_waitcnt lgkmcnt(0)
    s_add_u32 m0, s79, 24576
    s_add_u32 s78, s76, 163840
    buffer_load_dwordx4 v76, s[8:11], s78 offen offset:0 nt lds
    v_mov_b32 v56, s74
    s_waitcnt lgkmcnt(6)
    v_add_f32 v44, v44, v45
    v_add_f32 v46, v46, v47
    s_waitcnt lgkmcnt(4)
    v_add_f32 v48, v48, v49
    v_add_f32 v50, v50, v51
    v_add_f32 v44, v44, v46
    v_add_f32 v48, v48, v50
    v_mul_f32 v44, s73, v44
    v_fmac_f32 v56, s73, v48
    v_fma_f32 v56, -v44, v44, v56
    v_max_f32 v56, s74, v56
    v_rsq_f32 v56, v56
    s_waitcnt lgkmcnt(2)
    v_add_f32 v52, v52, v53
    v_add_f32 v54, v54, v55
    s_waitcnt lgkmcnt(0)
    v_add_f32 v40, v40, v41
    v_add_f32 v42, v42, v43
    v_add_f32 v52, v52, v54
    v_add_f32 v40, v40, v42
    v_fma_f32 v40, -v44, v52, v40
    v_mul_f32 v40, v40, v56
    s_nop 1
    v_mov_b32_dpp v42, v40 quad_perm:[1,0,3,2] row_mask:0xf bank_mask:0xf
    v_cvt_pk_bf16_f32 v41, v40, v42
    v_min_u32 v41, -2, v41
    s_lshl_b32 s67, s20, 12
    s_add_u32 s67, s67, 2818048
    s_lshl_b32 s60, s23, 7
    s_xor_b32 s61, s22, 2
    s_lshl_b32 s61, s61, 4
    s_add_u32 s60, s60, s61
    s_add_u32 s60, s60, s67
    s_cmp_eq_u32 s3, 0
    s_cselect_b64 exec, s[68:69], 0
    buffer_store_dword v41, v3, s[4:7], s60 offen sc1
    s_cselect_b64 exec, 1, 0
    global_atomic_add v8, v9, s[56:57] sc1
    s_mov_b64 exec, -1
    buffer_load_dwordx4 v77, s[8:11], s78 offen offset:1024 nt lds
    buffer_load_dwordx4 v78, s[8:11], s78 offen offset:2048 nt lds
    buffer_load_dwordx4 v79, s[8:11], s78 offen offset:3072 nt lds
    ds_read_b128 a[96:99], v72 offset:16384
    ds_read_b128 a[100:103], v73 offset:16384
    ds_read_b128 a[104:107], v74 offset:16384
    ds_read_b128 a[108:111], v75 offset:16384
    s_cmp_eq_u32 s51, 2
    s_cselect_b64 s[100:101], -1, 0
    s_lshl_b32 s61, s3, 12
    s_add_u32 m0, s61, 131072
    s_add_u32 s60, s39, 0
    s_mov_b64 exec, s[100:101]
    buffer_load_dwordx4 v85, s[88:91], s60 offen  lds
    s_mov_b64 exec, -1
    s_waitcnt lgkmcnt(0)
    s_add_u32 m0, s79, 28672
    s_add_u32 s78, s76, 180224
    buffer_load_dwordx4 v76, s[8:11], s78 offen offset:0 nt lds
    buffer_load_dwordx4 v77, s[8:11], s78 offen offset:1024 nt lds
    buffer_load_dwordx4 v78, s[8:11], s78 offen offset:2048 nt lds
    buffer_load_dwordx4 v79, s[8:11], s78 offen offset:3072 nt lds
    s_waitcnt vmcnt(22)
    ds_read_b128 a[112:115], v72 offset:4096
    ds_read_b128 a[116:119], v73 offset:4096
    ds_read_b128 a[120:123], v74 offset:4096
    ds_read_b128 a[124:127], v75 offset:4096
    s_cmp_eq_u32 s51, 3
    s_cselect_b64 s[100:101], -1, 0
    s_lshl_b32 s61, s3, 12
    s_add_u32 m0, s61, 131072
    s_add_u32 s60, s39, 0
    s_mov_b64 exec, s[100:101]
    buffer_load_dwordx4 v85, s[88:91], s60 offen  lds
    s_mov_b64 exec, -1
    s_add_u32 m0, s79, 13312
    s_add_u32 s60, s40, 32768
    buffer_load_dwordx4 v93, s[96:99], s60 offen  lds
    s_waitcnt lgkmcnt(0)
    s_add_u32 m0, s79, 16384
    s_add_u32 s78, s76, 196608
    buffer_load_dwordx4 v76, s[8:11], s78 offen offset:0 nt lds
    buffer_load_dwordx4 v77, s[8:11], s78 offen offset:1024 nt lds
    buffer_load_dwordx4 v78, s[8:11], s78 offen offset:2048 nt lds
    buffer_load_dwordx4 v79, s[8:11], s78 offen offset:3072 nt lds
    s_waitcnt vmcnt(24)
    ds_read_b128 a[128:131], v72 offset:20480
    ds_read_b128 a[132:135], v73 offset:20480
    ds_read_b128 a[136:139], v74 offset:20480
    ds_read_b128 a[140:143], v75 offset:20480
    s_cmp_eq_u32 s51, 0
    s_cselect_b64 s[100:101], -1, 0
    s_lshl_b32 s61, s3, 12
    s_add_u32 m0, s61, 132096
    s_add_u32 s60, s39, 229376
    s_mov_b64 exec, s[100:101]
    buffer_load_dwordx4 v85, s[88:91], s60 offen  lds
    s_mov_b64 exec, -1
    s_waitcnt lgkmcnt(0)
    s_add_u32 m0, s79, 4096
    s_add_u32 s78, s76, 212992
    buffer_load_dwordx4 v76, s[8:11], s78 offen offset:0 nt lds
    buffer_load_dwordx4 v77, s[8:11], s78 offen offset:1024 nt lds
    buffer_load_dwordx4 v78, s[8:11], s78 offen offset:2048 nt lds
    buffer_load_dwordx4 v79, s[8:11], s78 offen offset:3072 nt lds
    s_waitcnt vmcnt(24)
    ds_read_b128 a[144:147], v72 offset:8192
    ds_read_b128 a[148:151], v73 offset:8192
    ds_read_b128 a[152:155], v74 offset:8192
    ds_read_b128 a[156:159], v75 offset:8192
    s_cmp_eq_u32 s51, 1
    s_cselect_b64 s[100:101], -1, 0
    s_lshl_b32 s61, s3, 12
    s_add_u32 m0, s61, 132096
    s_add_u32 s60, s39, 229376
    s_mov_b64 exec, s[100:101]
    buffer_load_dwordx4 v85, s[88:91], s60 offen  lds
    s_mov_b64 exec, -1
    s_add_u32 m0, s79, 14336
    s_add_u32 s60, s40, 65536
    buffer_load_dwordx4 v93, s[96:99], s60 offen  lds
    s_waitcnt lgkmcnt(0)
    s_add_u32 m0, s79, 20480
    s_add_u32 s78, s76, 229376
    buffer_load_dwordx4 v76, s[8:11], s78 offen offset:0 nt lds
    buffer_load_dwordx4 v77, s[8:11], s78 offen offset:1024 nt lds
    buffer_load_dwordx4 v78, s[8:11], s78 offen offset:2048 nt lds
    buffer_load_dwordx4 v79, s[8:11], s78 offen offset:3072 nt lds
    s_waitcnt vmcnt(22)
    ds_read_b128 a[160:163], v72 offset:24576
    ds_read_b128 a[164:167], v73 offset:24576
    ds_read_b128 a[168:171], v74 offset:24576
    ds_read_b128 a[172:175], v75 offset:24576
    s_cmp_eq_u32 s51, 2
    s_cselect_b64 s[100:101], -1, 0
    s_lshl_b32 s61, s3, 12
    s_add_u32 m0, s61, 132096
    s_add_u32 s60, s39, 229376
    s_mov_b64 exec, s[100:101]
    buffer_load_dwordx4 v85, s[88:91], s60 offen  lds
    s_mov_b64 exec, -1
    s_waitcnt lgkmcnt(0)
    s_add_u32 m0, s79, 8192
    s_add_u32 s78, s76, 245760
    buffer_load_dwordx4 v76, s[8:11], s78 offen offset:0 nt lds
    buffer_load_dwordx4 v77, s[8:11], s78 offen offset:1024 nt lds
    buffer_load_dwordx4 v78, s[8:11], s78 offen offset:2048 nt lds
    buffer_load_dwordx4 v79, s[8:11], s78 offen offset:3072 nt lds
    s_waitcnt vmcnt(22)
    ds_read_b128 a[176:179], v72 offset:28672
    ds_read_b128 a[180:183], v73 offset:28672
    ds_read_b128 a[184:187], v74 offset:28672
    ds_read_b128 a[188:191], v75 offset:28672
    s_cmp_eq_u32 s51, 3
    s_cselect_b64 s[100:101], -1, 0
    s_lshl_b32 s61, s3, 12
    s_add_u32 m0, s61, 132096
    s_add_u32 s60, s39, 229376
    s_mov_b64 exec, s[100:101]
    buffer_load_dwordx4 v85, s[88:91], s60 offen  lds
    s_mov_b64 exec, -1
    s_add_u32 m0, s79, 15360
    s_add_u32 s60, s40, 98304
    buffer_load_dwordx4 v93, s[96:99], s60 offen  lds
    s_add_u32 m0, s79, 0
    s_add_u32 s78, s76, 0
    buffer_load_dwordx4 v88, s[12:15], s78 offen offset:0 nt lds
    buffer_load_dwordx4 v88, s[12:15], s78 offen offset:2048 nt lds
    s_add_u32 m0, m0, 896
    s_nop 0
    buffer_load_dwordx4 v88, s[12:15], s78 offen offset:128 nt lds
    buffer_load_dwordx4 v88, s[12:15], s78 offen offset:2176 nt lds
    s_cmp_eq_u32 s51, 0
    s_cselect_b64 s[100:101], -1, 0
    s_lshl_b32 s61, s3, 12
    s_add_u32 m0, s61, 133120
    s_add_u32 s60, s39, 0
    s_mov_b64 exec, s[100:101]
    buffer_load_dwordx4 v85, s[92:95], s60 offen  lds
    s_mov_b64 exec, -1
    s_waitcnt vmcnt(23)
    ds_read_b128 a[192:195], v72 offset:16384
    ds_read_b128 a[196:199], v73 offset:16384
    ds_read_b128 a[200:203], v74 offset:16384
    ds_read_b128 a[204:207], v75 offset:16384
    v_and_b32 v87, 7, v0
    v_lshlrev_b32 v87, 5, v87
    global_load_dword v26, v87, s[56:57] sc1
    s_waitcnt lgkmcnt(0)
    s_add_u32 m0, s79, 16384
    s_add_u32 s78, s76, 65536
    buffer_load_dwordx4 v88, s[12:15], s78 offen offset:0 nt lds
    buffer_load_dwordx4 v88, s[12:15], s78 offen offset:2048 nt lds
    s_add_u32 m0, m0, 896
    s_nop 0
    buffer_load_dwordx4 v88, s[12:15], s78 offen offset:128 nt lds
    buffer_load_dwordx4 v88, s[12:15], s78 offen offset:2176 nt lds
    s_cmp_eq_u32 s51, 1
    s_cselect_b64 s[100:101], -1, 0
    s_lshl_b32 s61, s3, 12
    s_add_u32 m0, s61, 133120
    s_add_u32 s60, s39, 0
    s_mov_b64 exec, s[100:101]
    buffer_load_dwordx4 v85, s[92:95], s60 offen  lds
    s_mov_b64 exec, -1
    s_waitcnt vmcnt(24)
    ds_read_b128 a[208:211], v72 offset:4096
    ds_read_b128 a[212:215], v73 offset:4096
    ds_read_b128 a[216:219], v74 offset:4096
    ds_read_b128 a[220:223], v75 offset:4096
    s_waitcnt lgkmcnt(0)
    s_add_u32 m0, s79, 4096
    s_add_u32 s78, s76, 16384
    buffer_load_dwordx4 v88, s[12:15], s78 offen offset:0 nt lds
    buffer_load_dwordx4 v88, s[12:15], s78 offen offset:2048 nt lds
    s_add_u32 m0, m0, 896
    s_nop 0
    buffer_load_dwordx4 v88, s[12:15], s78 offen offset:128 nt lds
    buffer_load_dwordx4 v88, s[12:15], s78 offen offset:2176 nt lds
    s_cmp_eq_u32 s51, 2
    s_cselect_b64 s[100:101], -1, 0
    s_lshl_b32 s61, s3, 12
    s_add_u32 m0, s61, 133120
    s_add_u32 s60, s39, 0
    s_mov_b64 exec, s[100:101]
    buffer_load_dwordx4 v85, s[92:95], s60 offen  lds
    s_mov_b64 exec, -1
    s_waitcnt vmcnt(23)
    ds_read_b128 a[224:227], v72 offset:20480
    ds_read_b128 a[228:231], v73 offset:20480
    ds_read_b128 a[232:235], v74 offset:20480
    ds_read_b128 a[236:239], v75 offset:20480
    s_waitcnt lgkmcnt(0)
    s_add_u32 m0, s79, 20480
    s_add_u32 s78, s76, 81920
    buffer_load_dwordx4 v88, s[12:15], s78 offen offset:0 nt lds
    buffer_load_dwordx4 v88, s[12:15], s78 offen offset:2048 nt lds
    v_lshrrev_b32 v2, 2, v90
    v_lshl_add_u32 v2, v91, 2, v2
    v_and_b32 v3, 7, v2
    v_lshrrev_b32 v2, 3, v2
    v_lshlrev_b32 v2, 11, v2
    v_lshl_add_u32 v2, v3, 5, v2
    v_and_b32 v9, 3, v90
    v_lshl_add_u32 v2, v9, 3, v2
    v_add_u32 v2, s79, v2
    v_lshlrev_b32 v8, 4, v9
    v_add_u32 v8, 163072, v8
    s_lshl_b32 s60, s3, 2
    v_add_u32 v3, s60, v8
    v_mov_b32 v4, 0x40000
    v_cmp_gt_u32 vcc, 4, v0
    s_nop 1
    v_cndmask_b32 v3, v4, v3, vcc
    s_mul_i32 s60, s3, 2112
    s_add_u32 s60, s60, 154624
    v_mul_u32_u24 v4, 528, v9
    v_lshrrev_b32 v5, 2, v90
    v_lshl_add_u32 v4, v5, 6, v4
    v_lshl_add_u32 v4, v91, 4, v4
    v_add_u32 v4, s60, v4
    s_mul_i32 s60, s3, 528
    s_add_u32 s60, s60, 154624
    v_lshlrev_b32 v5, 3, v0
    v_add_u32 v5, s60, v5
    s_lshl_b32 s60, s3, 4
    s_add_u32 s60, s60, 163072
    v_mov_b32 v6, s60
    v_lshlrev_b32 v7, 10, v91
    v_bfe_u32 v86, v0, 2, 2
    v_lshl_add_u32 v7, v86, 8, v7
    v_lshl_add_u32 v7, v9, 2, v7
    v_and_b32 v86, 3, v90
    v_lshlrev_b32 v86, 4, v86
    v_lshl_add_u32 v86, v91, 6, v86
    s_add_u32 m0, m0, 896
    s_nop 0
    buffer_load_dwordx4 v88, s[12:15], s78 offen offset:128 nt lds
    buffer_load_dwordx4 v88, s[12:15], s78 offen offset:2176 nt lds
    s_cmp_eq_u32 s51, 3
    s_cselect_b64 s[100:101], -1, 0
    s_lshl_b32 s61, s3, 12
    s_add_u32 m0, s61, 133120
    s_add_u32 s60, s39, 0
    s_mov_b64 exec, s[100:101]
    buffer_load_dwordx4 v85, s[92:95], s60 offen  lds
    s_mov_b64 exec, -1
    s_waitcnt vmcnt(23)
    ds_read_b128 a[240:243], v72 offset:8192
    ds_read_b128 a[244:247], v73 offset:8192
    ds_read_b128 a[248:251], v74 offset:8192
    ds_read_b128 a[252:255], v75 offset:8192
    s_waitcnt lgkmcnt(0)
    s_lshl_b32 s67, s20, 12
    s_lshl_b32 s60, s22, 10
    s_add_u32 s67, s67, s60
    s_add_u32 s67, s67, 2818048
    s_waitcnt vmcnt(15)
    s_branch L_cnt_chk
L_cnt_retry:
    s_add_u32 s27, s27, 1
    s_cmp_gt_u32 s27, 400000
    s_cbranch_scc1 L_abort
    s_sleep 8
    global_load_dword v26, v87, s[56:57] sc1
    s_waitcnt vmcnt(0)
L_cnt_chk:
    v_and_b32 v28, 63, v26
    v_cmp_ne_u32 vcc, 32, v28
    s_cbranch_vccnz L_cnt_retry
    v_readlane_b32 s60, v26, s20
    s_lshl_b32 s61, s77, 5
    s_cmp_eq_u32 s60, s61
    s_cselect_b32 s25, 1, 0
    s_xor_b32 s49, s0, 0
    s_and_b32 s49, s49, 7
    buffer_load_dwordx4 v[10:13], v86, s[4:7], s67 offen offset:0 sc1
    buffer_load_dwordx4 v[14:17], v86, s[4:7], s67 offen offset:256 sc1
    buffer_load_dwordx4 v[18:21], v86, s[4:7], s67 offen offset:512 sc1
    buffer_load_dwordx4 v[22:25], v86, s[4:7], s67 offen offset:768 sc1
    s_add_u32 m0, s79, 8192
    s_add_u32 s78, s76, 32768
    buffer_load_dwordx4 v88, s[12:15], s78 offen offset:0 nt lds
    buffer_load_dwordx4 v88, s[12:15], s78 offen offset:2048 nt lds
    v_lshrrev_b32 v31, 2, v90
    v_lshl_add_u32 v31, v91, 3, v31
    v_lshlrev_b32 v31, 5, v31
    v_and_b32 v30, 3, v90
    v_lshl_add_u32 v31, v30, 3, v31
    v_add_u32 v31, s79, v31
    ds_read_b64_tr_b16 v[112:113], v31 offset:12288
    ds_read_b64_tr_b16 v[114:115], v31 offset:12416
    ds_read_b64_tr_b16 v[116:117], v31 offset:13312
    ds_read_b64_tr_b16 v[118:119], v31 offset:13440
    ds_read_b64_tr_b16 v[120:121], v31 offset:14336
    ds_read_b64_tr_b16 v[122:123], v31 offset:14464
    ds_read_b64_tr_b16 v[124:125], v31 offset:15360
    ds_read_b64_tr_b16 v[126:127], v31 offset:15488
    s_add_u32 m0, m0, 896
    s_nop 0
    buffer_load_dwordx4 v88, s[12:15], s78 offen offset:128 nt lds
    buffer_load_dwordx4 v88, s[12:15], s78 offen offset:2176 nt lds
    s_cmp_eq_u32 s51, 0
    s_cselect_b64 s[100:101], -1, 0
    s_lshl_b32 s61, s3, 12
    s_add_u32 m0, s61, 134144
    s_add_u32 s60, s39, 229376
    s_mov_b64 exec, s[100:101]
    buffer_load_dwordx4 v85, s[92:95], s60 offen  lds
    s_mov_b64 exec, -1
    s_add_u32 m0, s79, 24576
    s_add_u32 s78, s76, 98304
    buffer_load_dwordx4 v88, s[12:15], s78 offen offset:0 nt lds
    buffer_load_dwordx4 v88, s[12:15], s78 offen offset:2048 nt lds
    s_waitcnt vmcnt(22)
    ds_read_b64_tr_b16 v[128:129], v2 offset:0
    ds_read_b64_tr_b16 v[130:131], v2 offset:16384
    ds_read_b64_tr_b16 v[132:133], v2 offset:256
    ds_read_b64_tr_b16 v[134:135], v2 offset:16640
    ds_read_b64_tr_b16 v[136:137], v2 offset:512
    ds_read_b64_tr_b16 v[138:139], v2 offset:16896
    ds_read_b64_tr_b16 v[140:141], v2 offset:768
    ds_read_b64_tr_b16 v[142:143], v2 offset:17152
    ds_read_b64_tr_b16 v[144:145], v2 offset:1024
    ds_read_b64_tr_b16 v[146:147], v2 offset:17408
    ds_read_b64_tr_b16 v[148:149], v2 offset:1280
    ds_read_b64_tr_b16 v[150:151], v2 offset:17664
    ds_read_b64_tr_b16 v[152:153], v2 offset:1536
    ds_read_b64_tr_b16 v[154:155], v2 offset:17920
    ds_read_b64_tr_b16 v[156:157], v2 offset:1792
    ds_read_b64_tr_b16 v[158:159], v2 offset:18176
    s_add_u32 m0, m0, 896
    s_nop 0
    buffer_load_dwordx4 v88, s[12:15], s78 offen offset:128 nt lds
    buffer_load_dwordx4 v88, s[12:15], s78 offen offset:2176 nt lds
    s_cmp_eq_u32 s51, 1
    s_cselect_b64 s[100:101], -1, 0
    s_lshl_b32 s61, s3, 12
    s_add_u32 m0, s61, 134144
    s_add_u32 s60, s39, 229376
    s_mov_b64 exec, s[100:101]
    buffer_load_dwordx4 v85, s[92:95], s60 offen  lds
    s_mov_b64 exec, -1
    s_waitcnt lgkmcnt(0)
    s_add_u32 m0, s79, 12288
    s_add_u32 s78, s76, 49152
    buffer_load_dwordx4 v88, s[12:15], s78 offen offset:0 nt lds
    buffer_load_dwordx4 v88, s[12:15], s78 offen offset:2048 nt lds
    s_waitcnt vmcnt(17)
    ds_read_b64_tr_b16 v[160:161], v2 offset:4096
    ds_read_b64_tr_b16 v[162:163], v2 offset:20480
    ds_read_b64_tr_b16 v[164:165], v2 offset:4352
    ds_read_b64_tr_b16 v[166:167], v2 offset:20736
    ds_read_b64_tr_b16 v[168:169], v2 offset:4608
    ds_read_b64_tr_b16 v[170:171], v2 offset:20992
    ds_read_b64_tr_b16 v[172:173], v2 offset:4864
    ds_read_b64_tr_b16 v[174:175], v2 offset:21248
    ds_read_b64_tr_b16 v[176:177], v2 offset:5120
    ds_read_b64_tr_b16 v[178:179], v2 offset:21504
    ds_read_b64_tr_b16 v[180:181], v2 offset:5376
    ds_read_b64_tr_b16 v[182:183], v2 offset:21760
    ds_read_b64_tr_b16 v[184:185], v2 offset:5632
    ds_read_b64_tr_b16 v[186:187], v2 offset:22016
    ds_read_b64_tr_b16 v[188:189], v2 offset:5888
    ds_read_b64_tr_b16 v[190:191], v2 offset:22272
    s_add_u32 m0, m0, 896
    s_nop 0
    buffer_load_dwordx4 v88, s[12:15], s78 offen offset:128 nt lds
    buffer_load_dwordx4 v88, s[12:15], s78 offen offset:2176 nt lds
    s_cmp_eq_u32 s51, 2
    s_cselect_b64 s[100:101], -1, 0
    s_lshl_b32 s61, s3, 12
    s_add_u32 m0, s61, 134144
    s_add_u32 s60, s39, 229376
    s_mov_b64 exec, s[100:101]
    buffer_load_dwordx4 v85, s[92:95], s60 offen  lds
    s_mov_b64 exec, -1
    s_add_u32 m0, s79, 28672
    s_add_u32 s78, s76, 114688
    buffer_load_dwordx4 v88, s[12:15], s78 offen offset:0 nt lds
    buffer_load_dwordx4 v88, s[12:15], s78 offen offset:2048 nt lds
    s_add_u32 m0, m0, 896
    s_nop 0
    buffer_load_dwordx4 v88, s[12:15], s78 offen offset:128 nt lds
    buffer_load_dwordx4 v88, s[12:15], s78 offen offset:2176 nt lds
    s_cmp_eq_u32 s51, 3
    s_cselect_b64 s[100:101], -1, 0
    s_lshl_b32 s61, s3, 12
    s_add_u32 m0, s61, 134144
    s_add_u32 s60, s39, 229376
    s_mov_b64 exec, s[100:101]
    buffer_load_dwordx4 v85, s[92:95], s60 offen  lds
    s_mov_b64 exec, -1
    s_waitcnt lgkmcnt(0)
    s_add_u32 m0, s79, 0
    s_add_u32 s78, s76, 131072
    buffer_load_dwordx4 v88, s[12:15], s78 offen offset:0 nt lds
    buffer_load_dwordx4 v88, s[12:15], s78 offen offset:2048 nt lds
    s_waitcnt vmcnt(13)
    ds_read_b64_tr_b16 v[192:193], v2 offset:8192
    ds_read_b64_tr_b16 v[194:195], v2 offset:24576
    ds_read_b64_tr_b16 v[196:197], v2 offset:8448
    ds_read_b64_tr_b16 v[198:199], v2 offset:24832
    ds_read_b64_tr_b16 v[200:201], v2 offset:8704
    ds_read_b64_tr_b16 v[202:203], v2 offset:25088
    ds_read_b64_tr_b16 v[204:205], v2 offset:8960
    ds_read_b64_tr_b16 v[206:207], v2 offset:25344
    ds_read_b64_tr_b16 v[208:209], v2 offset:9216
    ds_read_b64_tr_b16 v[210:211], v2 offset:25600
    ds_read_b64_tr_b16 v[212:213], v2 offset:9472
    ds_read_b64_tr_b16 v[214:215], v2 offset:25856
    ds_read_b64_tr_b16 v[216:217], v2 offset:9728
    ds_read_b64_tr_b16 v[218:219], v2 offset:26112
    ds_read_b64_tr_b16 v[220:221], v2 offset:9984
    ds_read_b64_tr_b16 v[222:223], v2 offset:26368
    s_add_u32 m0, m0, 896
    s_nop 0
    buffer_load_dwordx4 v88, s[12:15], s78 offen offset:128 nt lds
    buffer_load_dwordx4 v88, s[12:15], s78 offen offset:2176 nt lds
    s_add_u32 m0, s79, 16384
    s_add_u32 s78, s76, 196608
    buffer_load_dwordx4 v88, s[12:15], s78 offen offset:0 nt lds
    buffer_load_dwordx4 v88, s[12:15], s78 offen offset:2048 nt lds
    s_add_u32 m0, m0, 896
    s_nop 0
    buffer_load_dwordx4 v88, s[12:15], s78 offen offset:128 nt lds
    buffer_load_dwordx4 v88, s[12:15], s78 offen offset:2176 nt lds
    s_lshl_b32 s61, s3, 1
    s_add_u32 s61, s61, 0
    s_min_u32 s61, s61, 6
    s_lshl_b32 s60, s61, 10
    s_add_u32 m0, s60, 147456
    s_lshl_b32 s61, s61, 15
    s_add_u32 s60, s41, s61
    buffer_load_dwordx4 v93, s[16:19], s60 offen  lds
    s_waitcnt lgkmcnt(0)
    s_add_u32 m0, s79, 4096
    s_add_u32 s78, s76, 147456
    buffer_load_dwordx4 v88, s[12:15], s78 offen offset:0 nt lds
    buffer_load_dwordx4 v88, s[12:15], s78 offen offset:2048 nt lds
    s_waitcnt vmcnt(12)
    ds_read_b64_tr_b16 v[224:225], v2 offset:12288
    ds_read_b64_tr_b16 v[226:227], v2 offset:28672
    ds_read_b64_tr_b16 v[228:229], v2 offset:12544
    ds_read_b64_tr_b16 v[230:231], v2 offset:28928
    ds_read_b64_tr_b16 v[232:233], v2 offset:12800
    ds_read_b64_tr_b16 v[234:235], v2 offset:29184
    ds_read_b64_tr_b16 v[236:237], v2 offset:13056
    ds_read_b64_tr_b16 v[238:239], v2 offset:29440
    ds_read_b64_tr_b16 v[240:241], v2 offset:13312
    ds_read_b64_tr_b16 v[242:243], v2 offset:29696
    ds_read_b64_tr_b16 v[244:245], v2 offset:13568
    ds_read_b64_tr_b16 v[246:247], v2 offset:29952
    ds_read_b64_tr_b16 v[248:249], v2 offset:13824
    ds_read_b64_tr_b16 v[250:251], v2 offset:30208
    ds_read_b64_tr_b16 v[252:253], v2 offset:14080
    ds_read_b64_tr_b16 v[254:255], v2 offset:30464
    s_add_u32 m0, m0, 896
    s_nop 0
    buffer_load_dwordx4 v88, s[12:15], s78 offen offset:128 nt lds
    buffer_load_dwordx4 v88, s[12:15], s78 offen offset:2176 nt lds
    s_lshl_b32 s61, s3, 1
    s_add_u32 s61, s61, 1
    s_min_u32 s61, s61, 6
    s_lshl_b32 s60, s61, 10
    s_add_u32 m0, s60, 147456
    s_lshl_b32 s61, s61, 15
    s_add_u32 s60, s41, s61
    buffer_load_dwordx4 v93, s[16:19], s60 offen  lds
    s_add_u32 m0, s79, 20480
    s_add_u32 s78, s76, 212992
    buffer_load_dwordx4 v88, s[12:15], s78 offen offset:0 nt lds
    buffer_load_dwordx4 v88, s[12:15], s78 offen offset:2048 nt lds
    s_add_u32 m0, m0, 896
    s_nop 0
    buffer_load_dwordx4 v88, s[12:15], s78 offen offset:128 nt lds
    buffer_load_dwordx4 v88, s[12:15], s78 offen offset:2176 nt lds
    s_add_u32 s62, s24, 0
    s_add_u32 s63, s24, 65536
    s_add_u32 s64, s24, 71680
    s_add_u32 s65, s24, 83968
    s_mov_b32 s60, s21
    s_lshr_b32 s75, s60, 2
    s_lshl_b32 s75, s75, 14
    s_and_b32 s60, s60, 3
    s_lshl_b32 s60, s60, 11
    s_add_u32 s75, s75, s60
    s_lshl_b32 s61, s20, 7
    s_xor_b32 s60, s21, 16
    s_lshr_b32 s66, s60, 2
    s_lshl_b32 s66, s66, 14
    s_and_b32 s60, s60, 3
    s_lshl_b32 s60, s60, 11
    s_add_u32 s66, s66, s60
    s_add_u32 s66, s66, s61
    s_xor_b32 s60, s21, 16
    s_lshr_b32 s48, s60, 2
    s_lshl_b32 s48, s48, 14
    s_and_b32 s60, s60, 3
    s_lshl_b32 s60, s60, 11
    s_add_u32 s48, s48, s60
    s_add_u32 s48, s48, s61
    s_add_u32 s48, s48, 0x20000
    s_lshl_b32 s36, s3, 13
    s_lshr_b32 s60, s23, 2
    s_lshl_b32 s60, s60, 12
    s_add_u32 s36, s36, s60
    s_and_b32 s60, s23, 3
    s_lshl_b32 s61, s22, 2
    s_add_u32 s60, s60, s61
    s_lshl_b32 s60, s60, 4
    s_add_u32 s36, s36, s60
    s_add_u32 s36, s36, s62
    s_lshl_b32 s37, s22, 8
    s_lshl_b32 s60, s3, 6
    s_add_u32 s37, s37, s60
    s_lshl_b32 s60, s23, 3
    s_add_u32 s37, s37, s60
    s_add_u32 s37, s37, s63
    s_branch L_att
L_hook0:
    s_waitcnt lgkmcnt(0)
    s_add_u32 m0, s79, 8192
    s_add_u32 s60, s76, 163840
    buffer_load_dwordx4 v88, s[12:15], s60 offen offset:0 nt lds
    s_cmp_eq_u32 s26, 0
    s_branch L_hook0_done
L_hook1:
    s_add_u32 m0, s79, 8192
    s_add_u32 s60, s76, 163840
    buffer_load_dwordx4 v88, s[12:15], s60 offen offset:2048 nt lds
    s_cmp_eq_u32 s26, 0
    s_branch L_hook1_done
L_hook2:
    s_add_u32 m0, s79, 9088
    s_add_u32 s60, s76, 163840
    buffer_load_dwordx4 v88, s[12:15], s60 offen offset:128 nt lds
    s_cmp_eq_u32 s26, 0
    s_branch L_hook2_done
L_hook3:
    s_add_u32 m0, s79, 9088
    s_add_u32 s60, s76, 163840
    buffer_load_dwordx4 v88, s[12:15], s60 offen offset:2176 nt lds
    s_cmp_eq_u32 s26, 0
    s_branch L_hook3_done
L_rest:
    s_add_u32 m0, s79, 24576
    s_add_u32 s78, s76, 229376
    buffer_load_dwordx4 v88, s[12:15], s78 offen offset:0 nt lds
    buffer_load_dwordx4 v88, s[12:15], s78 offen offset:2048 nt lds
    s_add_u32 m0, m0, 896
    s_nop 0
    buffer_load_dwordx4 v88, s[12:15], s78 offen offset:128 nt lds
    buffer_load_dwordx4 v88, s[12:15], s78 offen offset:2176 nt lds
    v_min_u32 v87, 21, v0
    v_lshlrev_b32 v87, 7, v87
    s_mul_i32 s60, s21, 2816
    s_add_u32 s60, s60, s24
    s_mul_i32 s61, s3, 2112
    s_add_u32 m0, s61, 154624
    s_nop 0
    buffer_load_dword v87, s[4:7], s60 offen sc1 lds
    s_waitcnt lgkmcnt(0)
    s_add_u32 m0, s79, 12288
    s_add_u32 s78, s76, 180224
    buffer_load_dwordx4 v88, s[12:15], s78 offen offset:0 nt lds
    buffer_load_dwordx4 v88, s[12:15], s78 offen offset:2048 nt lds
    s_add_u32 m0, m0, 896
    s_nop 0
    buffer_load_dwordx4 v88, s[12:15], s78 offen offset:128 nt lds
    buffer_load_dwordx4 v88, s[12:15], s78 offen offset:2176 nt lds
    s_add_u32 m0, s79, 28672
    s_add_u32 s78, s76, 245760
    buffer_load_dwordx4 v88, s[12:15], s78 offen offset:0 nt lds
    buffer_load_dwordx4 v88, s[12:15], s78 offen offset:2048 nt lds
    s_add_u32 m0, m0, 896
    s_nop 0
    buffer_load_dwordx4 v88, s[12:15], s78 offen offset:128 nt lds
    buffer_load_dwordx4 v88, s[12:15], s78 offen offset:2176 nt lds
    s_cmp_eq_u32 s26, 0
    s_branch L_rest_done
    .p2align 6
L_att:
    v_cndmask_b32 v26, 0, v10, s[28:29]
    v_cndmask_b32 v27, 0, v11, s[28:29]
    v_cndmask_b32 v28, 0, v12, s[28:29]
    v_cndmask_b32 v29, 0, v13, s[28:29]
    s_nop 1
    v_mfma_f32_16x16x32_bf16 v[34:37], a[0:3], v[26:29], 0
    v_cndmask_b32 v30, 0, v14, s[28:29]
    v_cndmask_b32 v31, 0, v15, s[28:29]
    v_mfma_f32_16x16x32_bf16 v[38:41], a[64:67], v[26:29], 0
    v_cndmask_b32 v32, 0, v16, s[28:29]
    v_cndmask_b32 v33, 0, v17, s[28:29]
    v_mfma_f32_16x16x32_bf16 v[42:45], a[128:131], v[26:29], 0
    v_max3_u32 v9, v10, v11, v12
    v_max3_u32 v9, v9, v13, v14
    v_mfma_f32_16x16x32_bf16 v[46:49], a[192:195], v[26:29], 0
    v_max3_u32 v9, v9, v15, v16
    v_max3_u32 v9, v9, v17, v18
    v_mfma_f32_16x16x32_bf16 v[34:37], a[4:7], v[30:33], v[34:37]
    v_cndmask_b32 v26, 0, v18, s[28:29]
    v_cndmask_b32 v27, 0, v19, s[28:29]
    v_mfma_f32_16x16x32_bf16 v[38:41], a[68:71], v[30:33], v[38:41]
    v_cndmask_b32 v28, 0, v20, s[28:29]
    v_cndmask_b32 v29, 0, v21, s[28:29]
    v_mfma_f32_16x16x32_bf16 v[42:45], a[132:135], v[30:33], v[42:45]
    v_max3_u32 v9, v9, v19, v20
    v_max3_u32 v9, v9, v21, v22
    v_mfma_f32_16x16x32_bf16 v[46:49], a[196:199], v[30:33], v[46:49]
    v_max3_u32 v9, v9, v23, v24
    v_max_u32 v9, v9, v25
    v_mfma_f32_16x16x32_bf16 v[34:37], a[8:11], v[26:29], v[34:37]
    v_cndmask_b32 v30, 0, v22, s[28:29]
    v_cndmask_b32 v31, 0, v23, s[28:29]
    v_mfma_f32_16x16x32_bf16 v[38:41], a[72:75], v[26:29], v[38:41]
    v_cndmask_b32 v32, 0, v24, s[28:29]
    v_cndmask_b32 v33, 0, v25, s[28:29]
    v_mfma_f32_16x16x32_bf16 v[42:45], a[136:139], v[26:29], v[42:45]
    v_cmp_eq_u32 vcc, -1, v9
    v_mfma_f32_16x16x32_bf16 v[46:49], a[200:203], v[26:29], v[46:49]
    s_cbranch_vccnz L_retry_q2
    v_mfma_f32_16x16x32_bf16 v[34:37], a[12:15], v[30:33], v[34:37]
    v_cndmask_b32 v26, 0, v10, s[30:31]
    v_cndmask_b32 v27, 0, v11, s[30:31]
    s_cmp_eq_u32 s26, 0
    v_mfma_f32_16x16x32_bf16 v[38:41], a[76:79], v[30:33], v[38:41]
    v_cndmask_b32 v28, 0, v12, s[30:31]
    v_cndmask_b32 v29, 0, v13, s[30:31]
    v_mfma_f32_16x16x32_bf16 v[42:45], a[140:143], v[30:33], v[42:45]
    s_cbranch_scc1 L_hook0
L_hook0_done:
    v_mfma_f32_16x16x32_bf16 v[46:49], a[204:207], v[30:33], v[46:49]
    v_mfma_f32_16x16x32_bf16 v[34:37], a[16:19], v[26:29], v[34:37]
    v_cndmask_b32 v30, 0, v14, s[30:31]
    v_cndmask_b32 v31, 0, v15, s[30:31]
    v_mfma_f32_16x16x32_bf16 v[38:41], a[80:83], v[26:29], v[38:41]
    v_cndmask_b32 v32, 0, v16, s[30:31]
    v_cndmask_b32 v33, 0, v17, s[30:31]
    v_mfma_f32_16x16x32_bf16 v[42:45], a[144:147], v[26:29], v[42:45]
    v_mfma_f32_16x16x32_bf16 v[46:49], a[208:211], v[26:29], v[46:49]
    v_mfma_f32_16x16x32_bf16 v[34:37], a[20:23], v[30:33], v[34:37]
    v_cndmask_b32 v26, 0, v18, s[30:31]
    v_cndmask_b32 v27, 0, v19, s[30:31]
    v_mfma_f32_16x16x32_bf16 v[38:41], a[84:87], v[30:33], v[38:41]
    v_cndmask_b32 v28, 0, v20, s[30:31]
    v_cndmask_b32 v29, 0, v21, s[30:31]
    v_mfma_f32_16x16x32_bf16 v[42:45], a[148:151], v[30:33], v[42:45]
    v_mfma_f32_16x16x32_bf16 v[46:49], a[212:215], v[30:33], v[46:49]
    v_mfma_f32_16x16x32_bf16 v[34:37], a[24:27], v[26:29], v[34:37]
    v_cndmask_b32 v30, 0, v22, s[30:31]
    v_cndmask_b32 v31, 0, v23, s[30:31]
    v_mfma_f32_16x16x32_bf16 v[38:41], a[88:91], v[26:29], v[38:41]
    v_cndmask_b32 v32, 0, v24, s[30:31]
    v_cndmask_b32 v33, 0, v25, s[30:31]
    v_mfma_f32_16x16x32_bf16 v[42:45], a[152:155], v[26:29], v[42:45]
    v_mfma_f32_16x16x32_bf16 v[46:49], a[216:219], v[26:29], v[46:49]
    v_mfma_f32_16x16x32_bf16 v[34:37], a[28:31], v[30:33], v[34:37]
    v_cndmask_b32 v26, 0, v10, s[32:33]
    v_cndmask_b32 v27, 0, v11, s[32:33]
    v_mfma_f32_16x16x32_bf16 v[38:41], a[92:95], v[30:33], v[38:41]
    v_cndmask_b32 v28, 0, v12, s[32:33]
    v_cndmask_b32 v29, 0, v13, s[32:33]
    v_mfma_f32_16x16x32_bf16 v[42:45], a[156:159], v[30:33], v[42:45]
    s_cbranch_scc1 L_hook1
L_hook1_done:
    v_mfma_f32_16x16x32_bf16 v[46:49], a[220:223], v[30:33], v[46:49]
    v_mfma_f32_16x16x32_bf16 v[34:37], a[32:35], v[26:29], v[34:37]
    v_cndmask_b32 v30, 0, v14, s[32:33]
    v_cndmask_b32 v31, 0, v15, s[32:33]
    v_mfma_f32_16x16x32_bf16 v[38:41], a[96:99], v[26:29], v[38:41]
    v_cndmask_b32 v32, 0, v16, s[32:33]
    v_cndmask_b32 v33, 0, v17, s[32:33]
    v_mfma_f32_16x16x32_bf16 v[42:45], a[160:163], v[26:29], v[42:45]
    v_mfma_f32_16x16x32_bf16 v[46:49], a[224:227], v[26:29], v[46:49]
    v_mfma_f32_16x16x32_bf16 v[34:37], a[36:39], v[30:33], v[34:37]
    v_cndmask_b32 v26, 0, v18, s[32:33]
    v_cndmask_b32 v27, 0, v19, s[32:33]
    v_mfma_f32_16x16x32_bf16 v[38:41], a[100:103], v[30:33], v[38:41]
    v_cndmask_b32 v28, 0, v20, s[32:33]
    v_cndmask_b32 v29, 0, v21, s[32:33]
    v_mfma_f32_16x16x32_bf16 v[42:45], a[164:167], v[30:33], v[42:45]
    v_mfma_f32_16x16x32_bf16 v[46:49], a[228:231], v[30:33], v[46:49]
    v_mfma_f32_16x16x32_bf16 v[34:37], a[40:43], v[26:29], v[34:37]
    v_cndmask_b32 v30, 0, v22, s[32:33]
    v_cndmask_b32 v31, 0, v23, s[32:33]
    v_mfma_f32_16x16x32_bf16 v[38:41], a[104:107], v[26:29], v[38:41]
    v_cndmask_b32 v32, 0, v24, s[32:33]
    v_cndmask_b32 v33, 0, v25, s[32:33]
    v_mfma_f32_16x16x32_bf16 v[42:45], a[168:171], v[26:29], v[42:45]
    v_mfma_f32_16x16x32_bf16 v[46:49], a[232:235], v[26:29], v[46:49]
    v_mfma_f32_16x16x32_bf16 v[34:37], a[44:47], v[30:33], v[34:37]
    v_cndmask_b32 v26, 0, v10, s[34:35]
    v_cndmask_b32 v27, 0, v11, s[34:35]
    v_mfma_f32_16x16x32_bf16 v[38:41], a[108:111], v[30:33], v[38:41]
    v_cndmask_b32 v28, 0, v12, s[34:35]
    v_cndmask_b32 v29, 0, v13, s[34:35]
    v_mfma_f32_16x16x32_bf16 v[42:45], a[172:175], v[30:33], v[42:45]
    s_cbranch_scc1 L_hook2
L_hook2_done:
    v_mfma_f32_16x16x32_bf16 v[46:49], a[236:239], v[30:33], v[46:49]
    v_mfma_f32_16x16x32_bf16 v[34:37], a[48:51], v[26:29], v[34:37]
    v_cndmask_b32 v30, 0, v14, s[34:35]
    v_cndmask_b32 v31, 0, v15, s[34:35]
    v_mfma_f32_16x16x32_bf16 v[38:41], a[112:115], v[26:29], v[38:41]
    v_cndmask_b32 v32, 0, v16, s[34:35]
    v_cndmask_b32 v33, 0, v17, s[34:35]
    v_mfma_f32_16x16x32_bf16 v[42:45], a[176:179], v[26:29], v[42:45]
    v_mfma_f32_16x16x32_bf16 v[46:49], a[240:243], v[26:29], v[46:49]
    v_mfma_f32_16x16x32_bf16 v[34:37], a[52:55], v[30:33], v[34:37]
    v_cndmask_b32 v26, 0, v18, s[34:35]
    v_cndmask_b32 v27, 0, v19, s[34:35]
    v_mfma_f32_16x16x32_bf16 v[38:41], a[116:119], v[30:33], v[38:41]
    v_cndmask_b32 v28, 0, v20, s[34:35]
    v_cndmask_b32 v29, 0, v21, s[34:35]
    v_mfma_f32_16x16x32_bf16 v[42:45], a[180:183], v[30:33], v[42:45]
    v_mfma_f32_16x16x32_bf16 v[46:49], a[244:247], v[30:33], v[46:49]
    v_mfma_f32_16x16x32_bf16 v[34:37], a[56:59], v[26:29], v[34:37]
    v_cndmask_b32 v30, 0, v22, s[34:35]
    v_cndmask_b32 v31, 0, v23, s[34:35]
    v_mfma_f32_16x16x32_bf16 v[38:41], a[120:123], v[26:29], v[38:41]
    v_cndmask_b32 v32, 0, v24, s[34:35]
    v_cndmask_b32 v33, 0, v25, s[34:35]
    v_mfma_f32_16x16x32_bf16 v[42:45], a[184:187], v[26:29], v[42:45]
    v_mfma_f32_16x16x32_bf16 v[46:49], a[248:251], v[26:29], v[46:49]
    v_mfma_f32_16x16x32_bf16 v[34:37], a[60:63], v[30:33], v[34:37]
    v_mfma_f32_16x16x32_bf16 v[38:41], a[124:127], v[30:33], v[38:41]
    v_mfma_f32_16x16x32_bf16 v[42:45], a[188:191], v[30:33], v[42:45]
    s_cbranch_scc1 L_hook3
L_hook3_done:
    v_mfma_f32_16x16x32_bf16 v[46:49], a[252:255], v[30:33], v[46:49]
    s_cbranch_scc1 L_rest
L_rest_done:
    s_waitcnt vmcnt(27)
    s_nop 1
    v_max3_f32 v94, v34, v35, v36
    v_max3_f32 v93, v37, v38, v39
    v_max3_f32 v94, v94, v40, v41
    v_max3_f32 v93, v93, v42, v43
    v_max3_f32 v94, v94, v44, v45
    v_max3_f32 v93, v93, v46, v47
    v_max3_f32 v94, v94, v48, v49
    v_max_f32 v94, v94, v93
    ds_read_b64_tr_b16 v[10:11], v2 offset:0
    ds_read_b64_tr_b16 v[12:13], v2 offset:16384
    v_max_f32_dpp v94, v94, v94 row_ror:4 row_mask:0xf bank_mask:0xf
    ds_read_b64_tr_b16 v[14:15], v2 offset:256
    ds_read_b64_tr_b16 v[16:17], v2 offset:16640
    v_max_f32_dpp v94, v94, v94 row_ror:8 row_mask:0xf bank_mask:0xf
    v_mov_b32 v93, v94
    ds_read_b64_tr_b16 v[18:19], v2 offset:512
    ds_read_b64_tr_b16 v[20:21], v2 offset:16896
    v_permlane16_swap_b32 v94, v93
    v_max_f32 v94, v94, v93
    v_mov_b32 v93, v94
    ds_read_b64_tr_b16 v[22:23], v2 offset:768
    ds_read_b64_tr_b16 v[24:25], v2 offset:17152
    v_permlane32_swap_b32 v94, v93
    v_max_f32 v94, v94, v93
    v_mul_f32 v94, s72, v94
    v_pk_mul_f32 v[26:27], 0, 0
    v_pk_mul_f32 v[28:29], 0, 0
    v_pk_mul_f32 v[30:31], 0, 0
    v_pk_mul_f32 v[32:33], 0, 0
    v_pk_fma_f32 v[34:35], v[34:35], s[44:45], v[94:95] op_sel_hi:[1,1,0] neg_lo:[0,0,1] neg_hi:[0,0,1]
    v_pk_fma_f32 v[36:37], v[36:37], s[44:45], v[94:95] op_sel_hi:[1,1,0] neg_lo:[0,0,1] neg_hi:[0,0,1]
    v_pk_fma_f32 v[38:39], v[38:39], s[44:45], v[94:95] op_sel_hi:[1,1,0] neg_lo:[0,0,1] neg_hi:[0,0,1]
    v_pk_fma_f32 v[40:41], v[40:41], s[44:45], v[94:95] op_sel_hi:[1,1,0] neg_lo:[0,0,1] neg_hi:[0,0,1]
    v_pk_fma_f32 v[42:43], v[42:43], s[44:45], v[94:95] op_sel_hi:[1,1,0] neg_lo:[0,0,1] neg_hi:[0,0,1]
    v_pk_fma_f32 v[44:45], v[44:45], s[44:45], v[94:95] op_sel_hi:[1,1,0] neg_lo:[0,0,1] neg_hi:[0,0,1]
    v_pk_fma_f32 v[46:47], v[46:47], s[44:45], v[94:95] op_sel_hi:[1,1,0] neg_lo:[0,0,1] neg_hi:[0,0,1]
    v_pk_fma_f32 v[48:49], v[48:49], s[44:45], v[94:95] op_sel_hi:[1,1,0] neg_lo:[0,0,1] neg_hi:[0,0,1]
    ds_write_b32 v3, v94
    v_exp_f32 v34, v34
    v_exp_f32 v35, v35
    v_exp_f32 v36, v36
    v_exp_f32 v37, v37
    v_exp_f32 v38, v38
    v_exp_f32 v39, v39
    v_exp_f32 v40, v40
    v_exp_f32 v41, v41
    v_cvt_pk_bf16_f32 v82, v34, v35
    v_cvt_pk_bf16_f32 v83, v36, v37
    v_cvt_pk_bf16_f32 v84, v38, v39
    v_cvt_pk_bf16_f32 v85, v40, v41
    v_mov_b32_dpp v26, v82 quad_perm:[0,1,2,3] row_mask:0xf bank_mask:0x1
    v_mov_b32_dpp v27, v83 quad_perm:[0,1,2,3] row_mask:0xf bank_mask:0x1
    v_mov_b32_dpp v28, v84 quad_perm:[0,1,2,3] row_mask:0xf bank_mask:0x1
    v_mov_b32_dpp v29, v85 quad_perm:[0,1,2,3] row_mask:0xf bank_mask:0x1
    s_nop 1
    v_mfma_f32_16x16x32_bf16 v[50:53], v[128:131], v[26:29], 0
    v_exp_f32 v42, v42
    v_mfma_f32_16x16x32_bf16 v[54:57], v[132:135], v[26:29], 0
    v_mov_b32_dpp v30, v82 row_shl:4 row_mask:0xf bank_mask:0x1
    v_mov_b32_dpp v31, v83 row_shl:4 row_mask:0xf bank_mask:0x1
    v_mfma_f32_16x16x32_bf16 v[58:61], v[136:139], v[26:29], 0
    v_mov_b32_dpp v32, v84 row_shl:4 row_mask:0xf bank_mask:0x1
    v_mov_b32_dpp v33, v85 row_shl:4 row_mask:0xf bank_mask:0x1
    v_mfma_f32_16x16x32_bf16 v[62:65], v[140:143], v[26:29], 0
    v_exp_f32 v43, v43
    v_mfma_f32_16x16x32_bf16 v[66:69], v[144:147], v[26:29], 0
    v_exp_f32 v44, v44
    v_mfma_f32_16x16x32_bf16 v[70:73], v[148:151], v[26:29], 0
    v_exp_f32 v45, v45
    v_mfma_f32_16x16x32_bf16 v[74:77], v[152:155], v[26:29], 0
    v_exp_f32 v46, v46
    v_mfma_f32_16x16x32_bf16 v[78:81], v[156:159], v[26:29], 0
    v_exp_f32 v47, v47
    v_mfma_f32_16x16x32_bf16 v[50:53], v[160:163], v[30:33], v[50:53]
    v_exp_f32 v48, v48
    v_mfma_f32_16x16x32_bf16 v[54:57], v[164:167], v[30:33], v[54:57]
    v_mov_b32_dpp v26, v82 row_shl:8 row_mask:0xf bank_mask:0x1
    v_mov_b32_dpp v27, v83 row_shl:8 row_mask:0xf bank_mask:0x1
    v_mfma_f32_16x16x32_bf16 v[58:61], v[168:171], v[30:33], v[58:61]
    v_mov_b32_dpp v28, v84 row_shl:8 row_mask:0xf bank_mask:0x1
    v_mov_b32_dpp v29, v85 row_shl:8 row_mask:0xf bank_mask:0x1
    v_mfma_f32_16x16x32_bf16 v[62:65], v[172:175], v[30:33], v[62:65]
    v_exp_f32 v49, v49
    v_cvt_pk_bf16_f32 v86, v42, v43
    v_mfma_f32_16x16x32_bf16 v[66:69], v[176:179], v[30:33], v[66:69]
    v_cvt_pk_bf16_f32 v87, v44, v45
    v_cvt_pk_bf16_f32 v88, v46, v47
    v_cvt_pk_bf16_f32 v89, v48, v49
    v_mfma_f32_16x16x32_bf16 v[70:73], v[180:183], v[30:33], v[70:73]
    v_add_f32 v93, v34, v35
    v_add_f32 v93, v93, v36
    v_add_f32 v93, v93, v37
    v_mfma_f32_16x16x32_bf16 v[74:77], v[184:187], v[30:33], v[74:77]
    v_add_f32 v93, v93, v38
    v_add_f32 v93, v93, v39
    v_add_f32 v93, v93, v40
    v_mfma_f32_16x16x32_bf16 v[78:81], v[188:191], v[30:33], v[78:81]
    v_add_f32 v93, v93, v41
    ds_read_b64_tr_b16 v[34:35], v2 offset:1024
    ds_read_b64_tr_b16 v[36:37], v2 offset:17408
    v_mfma_f32_16x16x32_bf16 v[50:53], v[192:195], v[26:29], v[50:53]
    ds_read_b64_tr_b16 v[38:39], v2 offset:1280
    ds_read_b64_tr_b16 v[40:41], v2 offset:17664
    v_add_f32 v93, v93, v42
    v_mfma_f32_16x16x32_bf16 v[54:57], v[196:199], v[26:29], v[54:57]
    v_add_f32 v93, v93, v43
    v_add_f32 v93, v93, v44
    v_add_f32 v93, v93, v45
    v_mfma_f32_16x16x32_bf16 v[58:61], v[200:203], v[26:29], v[58:61]
    v_add_f32 v93, v93, v46
    v_add_f32 v93, v93, v47
    v_add_f32 v93, v93, v48
    v_mfma_f32_16x16x32_bf16 v[62:65], v[204:207], v[26:29], v[62:65]
    v_add_f32 v93, v93, v49
    ds_read_b64_tr_b16 v[42:43], v2 offset:1536
    ds_read_b64_tr_b16 v[44:45], v2 offset:17920
    v_mfma_f32_16x16x32_bf16 v[66:69], v[208:211], v[26:29], v[66:69]
    v_mov_b32_dpp v30, v86 quad_perm:[0,1,2,3] row_mask:0xf bank_mask:0x1
    v_mov_b32_dpp v31, v87 quad_perm:[0,1,2,3] row_mask:0xf bank_mask:0x1
    ds_read_b64_tr_b16 v[46:47], v2 offset:1792
    v_mfma_f32_16x16x32_bf16 v[70:73], v[212:215], v[26:29], v[70:73]
    v_mov_b32_dpp v32, v88 quad_perm:[0,1,2,3] row_mask:0xf bank_mask:0x1
    v_mov_b32_dpp v33, v89 quad_perm:[0,1,2,3] row_mask:0xf bank_mask:0x1
    ds_read_b64_tr_b16 v[48:49], v2 offset:18176
    v_mfma_f32_16x16x32_bf16 v[74:77], v[216:219], v[26:29], v[74:77]
    v_mfma_f32_16x16x32_bf16 v[78:81], v[220:223], v[26:29], v[78:81]
    s_waitcnt vmcnt(17)
    s_waitcnt lgkmcnt(9)
    v_mfma_f32_16x16x32_bf16 v[50:53], v[10:13], v[30:33], v[50:53]
    ds_read_b64_tr_b16 v[10:11], v2 offset:4096
    ds_read_b64_tr_b16 v[12:13], v2 offset:20480
    v_mfma_f32_16x16x32_bf16 v[54:57], v[14:17], v[30:33], v[54:57]
    ds_read_b64_tr_b16 v[14:15], v2 offset:4352
    ds_read_b64_tr_b16 v[16:17], v2 offset:20736
    v_mfma_f32_16x16x32_bf16 v[58:61], v[18:21], v[30:33], v[58:61]
    ds_read_b64_tr_b16 v[18:19], v2 offset:4608
    ds_read_b64_tr_b16 v[20:21], v2 offset:20992
    v_mfma_f32_16x16x32_bf16 v[62:65], v[22:25], v[30:33], v[62:65]
    ds_read_b64_tr_b16 v[22:23], v2 offset:4864
    ds_read_b64_tr_b16 v[24:25], v2 offset:21248
    v_mov_b32_dpp v26, v82 row_shl:12 row_mask:0xf bank_mask:0x1
    s_waitcnt lgkmcnt(8)
    v_mfma_f32_16x16x32_bf16 v[66:69], v[34:37], v[30:33], v[66:69]
    ds_read_b64_tr_b16 v[34:35], v2 offset:5120
    ds_read_b64_tr_b16 v[36:37], v2 offset:21504
    v_mov_b32_dpp v27, v83 row_shl:12 row_mask:0xf bank_mask:0x1
    v_mfma_f32_16x16x32_bf16 v[70:73], v[38:41], v[30:33], v[70:73]
    ds_read_b64_tr_b16 v[38:39], v2 offset:5376
    ds_read_b64_tr_b16 v[40:41], v2 offset:21760
    v_mov_b32_dpp v28, v84 row_shl:12 row_mask:0xf bank_mask:0x1
    v_mfma_f32_16x16x32_bf16 v[74:77], v[42:45], v[30:33], v[74:77]
    ds_read_b64_tr_b16 v[42:43], v2 offset:5632
    ds_read_b64_tr_b16 v[44:45], v2 offset:22016
    v_mov_b32_dpp v29, v85 row_shl:12 row_mask:0xf bank_mask:0x1
    v_mfma_f32_16x16x32_bf16 v[78:81], v[46:49], v[30:33], v[78:81]
    ds_read_b64_tr_b16 v[46:47], v2 offset:5888
    ds_read_b64_tr_b16 v[48:49], v2 offset:22272
    s_barrier
    v_mfma_f32_16x16x32_bf16 v[50:53], v[224:227], v[26:29], v[50:53]
    v_mov_b32_dpp v30, v86 row_shl:4 row_mask:0xf bank_mask:0x1
    v_mov_b32_dpp v31, v87 row_shl:4 row_mask:0xf bank_mask:0x1
    v_mfma_f32_16x16x32_bf16 v[54:57], v[228:231], v[26:29], v[54:57]
    v_mov_b32_dpp v32, v88 row_shl:4 row_mask:0xf bank_mask:0x1
    v_mov_b32_dpp v33, v89 row_shl:4 row_mask:0xf bank_mask:0x1
    v_mfma_f32_16x16x32_bf16 v[58:61], v[232:235], v[26:29], v[58:61]
    v_add_f32_dpp v93, v93, v93 row_ror:4 row_mask:0xf bank_mask:0xf
    v_mfma_f32_16x16x32_bf16 v[62:65], v[236:239], v[26:29], v[62:65]
    s_nop 0
    v_add_f32_dpp v93, v93, v93 row_ror:8 row_mask:0xf bank_mask:0xf
    v_mov_b32 v9, v93
    v_mfma_f32_16x16x32_bf16 v[66:69], v[240:243], v[26:29], v[66:69]
    v_mfma_f32_16x16x32_bf16 v[70:73], v[244:247], v[26:29], v[70:73]
    v_permlane16_swap_b32 v93, v9
    v_add_f32 v93, v93, v9
    v_mfma_f32_16x16x32_bf16 v[74:77], v[248:251], v[26:29], v[74:77]
    v_mov_b32 v9, v93
    v_mfma_f32_16x16x32_bf16 v[78:81], v[252:255], v[26:29], v[78:81]
    s_waitcnt vmcnt(9)
    s_waitcnt lgkmcnt(8)
    v_mfma_f32_16x16x32_bf16 v[50:53], v[10:13], v[30:33], v[50:53]
    ds_read_b64_tr_b16 v[10:11], v2 offset:8192
    ds_read_b64_tr_b16 v[12:13], v2 offset:24576
    v_permlane32_swap_b32 v93, v9
    v_add_f32 v93, v93, v9
    v_mfma_f32_16x16x32_bf16 v[54:57], v[14:17], v[30:33], v[54:57]
    ds_read_b64_tr_b16 v[14:15], v2 offset:8448
    ds_read_b64_tr_b16 v[16:17], v2 offset:24832
    v_mfma_f32_16x16x32_bf16 v[58:61], v[18:21], v[30:33], v[58:61]
    ds_read_b64_tr_b16 v[18:19], v2 offset:8704
    ds_read_b64_tr_b16 v[20:21], v2 offset:25088
    v_mov_b32_dpp v26, v86 row_shl:8 row_mask:0xf bank_mask:0x1
    v_mfma_f32_16x16x32_bf16 v[62:65], v[22:25], v[30:33], v[62:65]
    ds_read_b64_tr_b16 v[22:23], v2 offset:8960
    ds_read_b64_tr_b16 v[24:25], v2 offset:25344
    v_mov_b32_dpp v27, v87 row_shl:8 row_mask:0xf bank_mask:0x1
    s_waitcnt lgkmcnt(8)
    v_mfma_f32_16x16x32_bf16 v[66:69], v[34:37], v[30:33], v[66:69]
    ds_read_b64_tr_b16 v[34:35], v2 offset:9216
    ds_read_b64_tr_b16 v[36:37], v2 offset:25600
    v_mov_b32_dpp v28, v88 row_shl:8 row_mask:0xf bank_mask:0x1
    v_mfma_f32_16x16x32_bf16 v[70:73], v[38:41], v[30:33], v[70:73]
    ds_read_b64_tr_b16 v[38:39], v2 offset:9472
    ds_read_b64_tr_b16 v[40:41], v2 offset:25856
    v_mov_b32_dpp v29, v89 row_shl:8 row_mask:0xf bank_mask:0x1
    v_mfma_f32_16x16x32_bf16 v[74:77], v[42:45], v[30:33], v[74:77]
    ds_read_b64_tr_b16 v[42:43], v2 offset:9728
    ds_read_b64_tr_b16 v[44:45], v2 offset:26112
    ds_read_b128 v[82:85], v8
    v_mfma_f32_16x16x32_bf16 v[78:81], v[46:49], v[30:33], v[78:81]
    ds_read_b64_tr_b16 v[46:47], v2 offset:9984
    ds_read_b64_tr_b16 v[48:49], v2 offset:26368
    s_waitcnt vmcnt(0)
    s_waitcnt lgkmcnt(9)
    v_mfma_f32_16x16x32_bf16 v[50:53], v[10:13], v[26:29], v[50:53]
    ds_read_b64_tr_b16 v[10:11], v2 offset:12288
    ds_read_b64_tr_b16 v[12:13], v2 offset:28672
    s_waitcnt lgkmcnt(4)
    v_max3_f32 v8, v82, v83, v84
    v_mfma_f32_16x16x32_bf16 v[54:57], v[14:17], v[26:29], v[54:57]
    ds_read_b64_tr_b16 v[14:15], v2 offset:12544
    ds_read_b64_tr_b16 v[16:17], v2 offset:28928
    v_max_f32 v8, v8, v85
    v_mfma_f32_16x16x32_bf16 v[58:61], v[18:21], v[26:29], v[58:61]
    ds_read_b64_tr_b16 v[18:19], v2 offset:12800
    ds_read_b64_tr_b16 v[20:21], v2 offset:29184
    v_mov_b32_dpp v30, v86 row_shl:12 row_mask:0xf bank_mask:0x1
    v_mfma_f32_16x16x32_bf16 v[62:65], v[22:25], v[26:29], v[62:65]
    ds_read_b64_tr_b16 v[22:23], v2 offset:13056
    ds_read_b64_tr_b16 v[24:25], v2 offset:29440
    v_mov_b32_dpp v31, v87 row_shl:12 row_mask:0xf bank_mask:0x1
    s_waitcnt lgkmcnt(8)
    v_mfma_f32_16x16x32_bf16 v[66:69], v[34:37], v[26:29], v[66:69]
    ds_read_b64_tr_b16 v[34:35], v2 offset:13312
    ds_read_b64_tr_b16 v[36:37], v2 offset:29696
    v_mov_b32_dpp v32, v88 row_shl:12 row_mask:0xf bank_mask:0x1
    v_mfma_f32_16x16x32_bf16 v[70:73], v[38:41], v[26:29], v[70:73]
    ds_read_b64_tr_b16 v[38:39], v2 offset:13568
    ds_read_b64_tr_b16 v[40:41], v2 offset:29952
    v_mov_b32_dpp v33, v89 row_shl:12 row_mask:0xf bank_mask:0x1
    v_mfma_f32_16x16x32_bf16 v[74:77], v[42:45], v[26:29], v[74:77]
    ds_read_b64_tr_b16 v[42:43], v2 offset:13824
    ds_read_b64_tr_b16 v[44:45], v2 offset:30208
    v_sub_f32 v9, v94, v8
    v_mfma_f32_16x16x32_bf16 v[78:81], v[46:49], v[26:29], v[78:81]
    ds_read_b64_tr_b16 v[46:47], v2 offset:14080
    ds_read_b64_tr_b16 v[48:49], v2 offset:30464
    v_exp_f32 v9, v9
    s_waitcnt lgkmcnt(8)
    v_mfma_f32_16x16x32_bf16 v[50:53], v[10:13], v[30:33], v[50:53]
    v_mfma_f32_16x16x32_bf16 v[54:57], v[14:17], v[30:33], v[54:57]
    ds_write2_b32 v3, v9, v93 offset0:16 offset1:32
    v_mfma_f32_16x16x32_bf16 v[58:61], v[18:21], v[30:33], v[58:61]
    v_mfma_f32_16x16x32_bf16 v[62:65], v[22:25], v[30:33], v[62:65]
    s_waitcnt lgkmcnt(1)
    v_mfma_f32_16x16x32_bf16 v[66:69], v[34:37], v[30:33], v[66:69]
    s_nop 2
    v_mov_b32_dpp v50, v54 row_shr:4 row_mask:0xf bank_mask:0x2
    v_mov_b32_dpp v51, v55 row_shr:4 row_mask:0xf bank_mask:0x2
    v_mfma_f32_16x16x32_bf16 v[70:73], v[38:41], v[30:33], v[70:73]
    v_mov_b32_dpp v52, v56 row_shr:4 row_mask:0xf bank_mask:0x2
    v_mov_b32_dpp v53, v57 row_shr:4 row_mask:0xf bank_mask:0x2
    v_mov_b32_dpp v50, v58 row_shr:8 row_mask:0xf bank_mask:0x4
    v_mfma_f32_16x16x32_bf16 v[74:77], v[42:45], v[30:33], v[74:77]
    v_mov_b32_dpp v51, v59 row_shr:8 row_mask:0xf bank_mask:0x4
    v_mov_b32_dpp v52, v60 row_shr:8 row_mask:0xf bank_mask:0x4
    v_mov_b32_dpp v53, v61 row_shr:8 row_mask:0xf bank_mask:0x4
    v_mfma_f32_16x16x32_bf16 v[78:81], v[46:49], v[30:33], v[78:81]
    v_mov_b32_dpp v50, v62 row_shr:12 row_mask:0xf bank_mask:0x8
    v_mov_b32_dpp v51, v63 row_shr:12 row_mask:0xf bank_mask:0x8
    v_mov_b32_dpp v52, v64 row_shr:12 row_mask:0xf bank_mask:0x8
    v_mov_b32_dpp v53, v65 row_shr:12 row_mask:0xf bank_mask:0x8
    ds_write_b128 v4, v[50:53]
    v_mov_b32_dpp v66, v70 row_shr:4 row_mask:0xf bank_mask:0x2
    v_mov_b32_dpp v67, v71 row_shr:4 row_mask:0xf bank_mask:0x2
    v_mov_b32_dpp v68, v72 row_shr:4 row_mask:0xf bank_mask:0x2
    v_mov_b32_dpp v69, v73 row_shr:4 row_mask:0xf bank_mask:0x2
    v_mov_b32_dpp v66, v74 row_shr:8 row_mask:0xf bank_mask:0x4
    v_mov_b32_dpp v67, v75 row_shr:8 row_mask:0xf bank_mask:0x4
    v_mov_b32_dpp v68, v76 row_shr:8 row_mask:0xf bank_mask:0x4
    v_mov_b32_dpp v69, v77 row_shr:8 row_mask:0xf bank_mask:0x4
    v_mov_b32_dpp v66, v78 row_shr:12 row_mask:0xf bank_mask:0x8
    v_mov_b32_dpp v67, v79 row_shr:12 row_mask:0xf bank_mask:0x8
    v_mov_b32_dpp v68, v80 row_shr:12 row_mask:0xf bank_mask:0x8
    v_mov_b32_dpp v69, v81 row_shr:12 row_mask:0xf bank_mask:0x8
    ds_write_b128 v4, v[66:69] offset:256
    s_cmp_eq_u32 s25, 1
    s_waitcnt lgkmcnt(0)
    s_barrier
    ds_read_b128 v[10:13], v6 offset:64
    ds_read_b64 v[18:19], v5 offset:0
    ds_read_b64 v[20:21], v5 offset:2112
    ds_read_b64 v[22:23], v5 offset:4224
    ds_read_b64 v[24:25], v5 offset:6336
    ds_read_b128 v[14:17], v6 offset:128
    s_waitcnt lgkmcnt(3)
    v_pk_mul_f32 v[18:19], v[18:19], v[10:11] op_sel_hi:[1,0]
    v_pk_fma_f32 v[18:19], v[20:21], v[10:11], v[18:19] op_sel:[0,1,0] op_sel_hi:[1,1,1]
    s_waitcnt lgkmcnt(1)
    v_pk_fma_f32 v[18:19], v[22:23], v[12:13], v[18:19] op_sel_hi:[1,0,1]
    v_pk_fma_f32 v[18:19], v[24:25], v[12:13], v[18:19] op_sel:[0,1,0] op_sel_hi:[1,1,1]
    v_cvt_pk_bf16_f32 v18, v18, v19
    v_min_u32 v18, -2, v18
    s_cbranch_scc0 L_slow_op
    buffer_store_dword v18, v7, s[4:7], s36 offen
L_sd_op:
    s_waitcnt lgkmcnt(0)
    v_mul_f32 v9, v10, v14
    v_fmac_f32 v9, v11, v15
    v_fmac_f32 v9, v12, v16
    v_fmac_f32 v9, v13, v17
    s_lshl_b64 exec, 1, s3
    s_cmp_eq_u32 s25, 1
    s_cbranch_scc0 L_slow_st
    buffer_store_dwordx2 v[8:9], off, s[4:7], s37
L_sd_st:
    s_mov_b64 exec, -1
    s_barrier
    s_lshl_b32 s61, s3, 6
    v_lshlrev_b32 v4, 8, v91
    v_add_u32 v4, s61, v4
    s_lshl_b32 s60, s3, 8
    s_add_u32 s60, s60, 158720
    v_lshlrev_b32 v5, 4, v90
    v_add_u32 v6, 158720, v5
    v_lshl_add_u32 v5, v91, 2, v5
    v_add_u32 v5, s60, v5
    v_lshlrev_b32 v7, 3, v90
    v_and_b32 v9, 1, v91
    v_lshl_add_u32 v7, v9, 10, v7
    v_lshrrev_b32 v9, 1, v91
    v_lshl_add_u32 v7, v9, 13, v7
    s_lshl_b32 s61, s3, 13
    s_add_u32 s61, s61, s62
    s_add_u32 s78, s61, 4096
    s_mov_b64 s[42:43], -1
    s_mov_b64 s[100:101], -1
    s_sleep 3
    s_branch L_poll_op
L_retry_op:
    s_add_u32 s27, s27, 1
    s_cmp_gt_u32 s27, 400000
    s_cbranch_scc1 L_abort
L_poll_op:
    buffer_load_dwordx4 v[42:45], v4, s[4:7], s63 offen offset:0 sc1
    buffer_load_dwordx4 v[46:49], v4, s[4:7], s63 offen offset:16 sc1
    buffer_load_dwordx4 v[50:53], v4, s[4:7], s63 offen offset:32 sc1
    buffer_load_dwordx4 v[54:57], v4, s[4:7], s63 offen offset:48 sc1
    s_mov_b64 exec, s[42:43]
    buffer_load_dwordx4 v[10:13], v92, s[4:7], s61 offen offset:0 sc1
    buffer_load_dwordx4 v[14:17], v92, s[4:7], s61 offen offset:1024 sc1
    buffer_load_dwordx4 v[18:21], v92, s[4:7], s61 offen offset:2048 sc1
    buffer_load_dwordx4 v[22:25], v92, s[4:7], s61 offen offset:3072 sc1
    s_mov_b64 exec, s[100:101]
    buffer_load_dwordx4 v[26:29], v92, s[4:7], s78 offen offset:0 sc1
    buffer_load_dwordx4 v[30:33], v92, s[4:7], s78 offen offset:1024 sc1
    buffer_load_dwordx4 v[34:37], v92, s[4:7], s78 offen offset:2048 sc1
    buffer_load_dwordx4 v[38:41], v92, s[4:7], s78 offen offset:3072 sc1
    s_mov_b64 exec, -1
    s_waitcnt vmcnt(8)
    v_max3_f32 v82, v42, v44, v46
    v_max3_f32 v83, v48, v50, v52
    v_max3_f32 v82, v82, v54, v56
    v_max_f32 v82, v82, v83
    v_max3_u32 v8, v42, v43, v44
    v_max3_u32 v8, v8, v45, v46
    v_max3_u32 v8, v8, v47, v48
    v_max3_u32 v8, v8, v49, v50
    v_max3_u32 v8, v8, v51, v52
    v_max3_u32 v8, v8, v53, v54
    v_max3_u32 v8, v8, v55, v56
    v_max_u32 v8, v8, v57
    v_sub_f32 v42, v42, v82
    v_sub_f32 v44, v44, v82
    v_sub_f32 v46, v46, v82
    v_sub_f32 v48, v48, v82
    v_sub_f32 v50, v50, v82
    v_sub_f32 v52, v52, v82
    v_sub_f32 v54, v54, v82
    v_sub_f32 v56, v56, v82
    v_exp_f32 v42, v42
    v_exp_f32 v44, v44
    v_exp_f32 v46, v46
    v_exp_f32 v48, v48
    v_exp_f32 v50, v50
    v_exp_f32 v52, v52
    v_exp_f32 v54, v54
    v_exp_f32 v56, v56
    v_mul_f32 v82, v42, v43
    v_mul_f32 v83, v44, v45
    v_fmac_f32 v82, v46, v47
    v_fmac_f32 v83, v48, v49
    v_fmac_f32 v82, v50, v51
    v_fmac_f32 v83, v52, v53
    v_fmac_f32 v82, v54, v55
    v_fmac_f32 v83, v56, v57
    v_add_f32 v82, v82, v83
    v_rcp_f32 v82, v82
    v_cmp_eq_u32 vcc, -1, v8
    s_waitcnt vmcnt(7)
    v_mfma_f32_16x16x32_bf16 v[74:77], v[10:13], v[112:115], 0
    v_max3_u32 v3, v10, v11, v12
    v_max_u32 v3, v3, v13
    s_waitcnt vmcnt(6)
    v_mfma_f32_16x16x32_bf16 v[74:77], v[14:17], v[116:119], v[74:77]
    v_max3_u32 v3, v3, v14, v15
    v_max3_u32 v3, v3, v16, v17
    s_waitcnt vmcnt(5)
    v_mfma_f32_16x16x32_bf16 v[74:77], v[18:21], v[120:123], v[74:77]
    v_max3_u32 v3, v3, v18, v19
    v_max3_u32 v3, v3, v20, v21
    s_waitcnt vmcnt(4)
    v_mfma_f32_16x16x32_bf16 v[74:77], v[22:25], v[124:127], v[74:77]
    v_max3_u32 v3, v3, v22, v23
    v_max3_u32 v3, v3, v24, v25
    s_waitcnt vmcnt(3)
    v_mfma_f32_16x16x32_bf16 v[78:81], v[26:29], v[112:115], 0
    v_max3_u32 v9, v26, v27, v28
    v_max_u32 v9, v9, v29
    v_cmp_eq_u32 s[42:43], -1, v3
    s_waitcnt vmcnt(2)
    v_mfma_f32_16x16x32_bf16 v[78:81], v[30:33], v[116:119], v[78:81]
    v_max3_u32 v9, v9, v30, v31
    v_max3_u32 v9, v9, v32, v33
    s_waitcnt vmcnt(1)
    v_mfma_f32_16x16x32_bf16 v[78:81], v[34:37], v[120:123], v[78:81]
    v_max3_u32 v9, v9, v34, v35
    v_max3_u32 v9, v9, v36, v37
    s_waitcnt vmcnt(0)
    v_mfma_f32_16x16x32_bf16 v[78:81], v[38:41], v[124:127], v[78:81]
    v_max3_u32 v9, v9, v38, v39
    v_max3_u32 v9, v9, v40, v41
    v_cmp_eq_u32 s[100:101], -1, v9
    s_or_b64 vcc, vcc, s[42:43]
    s_or_b64 vcc, vcc, s[100:101]
    s_cbranch_scc1 L_retry_op
    v_mul_f32 v83, v74, v42
    v_mul_f32 v84, v75, v44
    v_fmac_f32 v83, v76, v46
    v_fmac_f32 v84, v77, v48
    v_fmac_f32 v83, v78, v50
    v_fmac_f32 v84, v79, v52
    v_fmac_f32 v83, v80, v54
    v_fmac_f32 v84, v81, v56
    v_add_f32 v83, v83, v84
    v_mul_f32 v83, v83, v82
    ds_write_b32 v5, v83
    s_cmp_eq_u32 s3, 0
    s_waitcnt lgkmcnt(0)
    s_barrier
    s_cbranch_scc0 L_bx1
    ds_read_b128 v[10:13], v6 offset:0
    ds_read_b128 v[14:17], v6 offset:256
    ds_read_b128 v[18:21], v6 offset:512
    ds_read_b128 v[22:25], v6 offset:768
    s_waitcnt lgkmcnt(2)
    v_pk_add_f32 v[10:11], v[10:11], v[14:15]
    v_pk_add_f32 v[12:13], v[12:13], v[16:17]
    s_waitcnt lgkmcnt(0)
    v_pk_add_f32 v[18:19], v[18:19], v[22:23]
    v_pk_add_f32 v[20:21], v[20:21], v[24:25]
    v_pk_add_f32 v[10:11], v[10:11], v[18:19]
    v_pk_add_f32 v[12:13], v[12:13], v[20:21]
    v_cvt_pk_bf16_f32 v10, v10, v11
    v_cvt_pk_bf16_f32 v11, v12, v13
    v_pk_min_u16 v10, v10, -2 op_sel_hi:[1,0]
    v_pk_min_u16 v11, v11, -2 op_sel_hi:[1,0]
    buffer_store_dwordx2 v[10:11], v7, s[4:7], s66 offen sc1
    v_lshlrev_b32 v60, 3, v90
    v_lshl_add_u32 v60, v91, 1, v60
    v_mov_b32 v64, 0
    v_mov_b32 v65, 0
    v_mov_b32 v66, 0
    v_mov_b32 v67, 0
    v_mov_b32 v68, 0
    v_mov_b32 v69, 0
    v_mov_b32 v70, 0
    v_mov_b32 v71, 0
    v_lshrrev_b32 v61, 3, v90
    v_lshlrev_b32 v61, 6, v61
    v_lshl_add_u32 v61, v91, 4, v61
    v_and_b32 v59, 7, v90
    v_lshl_add_u32 v61, v59, 1, v61
    v_lshrrev_b32 v31, 2, v90
    v_lshl_add_u32 v31, v91, 3, v31
    v_lshlrev_b32 v31, 4, v31
    v_and_b32 v30, 1, v90
    v_lshl_add_u32 v31, v30, 3, v31
    v_bfe_u32 v30, v90, 1, 1
    v_lshl_add_u32 v31, v30, 11, v31
    s_lshl_b32 s60, s3, 12
    s_add_u32 s60, s60, 131072
    v_add_u32 v31, s60, v31
    ds_read_b64_tr_b16 v[74:75], v31 offset:0
    ds_read_b64_tr_b16 v[76:77], v31 offset:64
    ds_read_b64_tr_b16 v[78:79], v31 offset:512
    ds_read_b64_tr_b16 v[80:81], v31 offset:576
    ds_read_b64_tr_b16 v[82:83], v31 offset:1024
    ds_read_b64_tr_b16 v[84:85], v31 offset:1088
    ds_read_b64_tr_b16 v[86:87], v31 offset:1536
    ds_read_b64_tr_b16 v[88:89], v31 offset:1600
    v_lshlrev_b32 v31, 4, v91
    v_lshl_add_u32 v31, v90, 1, v31
    s_lshl_b32 s50, s21, 6
    s_add_u32 s50, s50, s65
    v_and_b32 v63, 3, v90
    v_lshlrev_b32 v63, 4, v63
    v_lshl_add_u32 v63, v91, 6, v63
    s_lshl_b32 s78, s3, 10
    s_add_u32 s78, s78, s64
    v_mov_b32 v10, 0x3f803f80
    v_mov_b32 v11, 0x3f803f80
    v_mov_b32 v12, 0x3f803f80
    v_mov_b32 v13, 0x3f803f80
    v_mov_b32 v14, 0x3f803f80
    v_mov_b32 v15, 0x3f803f80
    v_mov_b32 v16, 0x3f803f80
    v_mov_b32 v17, 0x3f803f80
    v_mov_b32 v18, 0x3f803f80
    v_mov_b32 v19, 0x3f803f80
    v_mov_b32 v20, 0x3f803f80
    v_mov_b32 v21, 0x3f803f80
    v_mov_b32 v22, 0x3f803f80
    v_mov_b32 v23, 0x3f803f80
    v_mov_b32 v24, 0x3f803f80
    v_mov_b32 v25, 0x3f803f80
    s_lshl_b32 s60, s3, 10
    s_add_u32 s60, s60, 154624
    v_add_u32 v26, s60, v92
    v_lshlrev_b32 v27, 4, v90
    v_add_u32 v28, 154880, v27
    v_lshl_add_u32 v27, v91, 2, v27
    v_add_u32 v27, 154624, v27
    v_lshlrev_b32 v29, 2, v91
    v_lshl_add_u32 v30, v91, 4, v29
    v_add_u32 v29, 155200, v29
    v_add_u32 v30, 155136, v30
    s_lshl_b32 s61, s21, 7
    s_add_u32 s61, s61, s64
    s_sleep 5
    s_and_b32 s60, s49, 1
    s_lshl_b32 s60, s60, 10
    s_lshr_b32 s100, s49, 2
    s_lshl_b32 s100, s100, 13
    s_add_u32 s60, s60, s100
    s_add_u32 s60, s60, s75
    s_branch L_poll_g1
L_retry_g1:
    s_add_u32 s27, s27, 1
    s_cmp_gt_u32 s27, 400000
    s_cbranch_scc1 L_abort
L_poll_g1:
    buffer_load_short_d16_hi v64, v60, s[4:7], s60 offen offset:0 sc1
    buffer_load_short_d16_hi v65, v60, s[4:7], s60 offen offset:128 sc1
    buffer_load_short_d16_hi v66, v60, s[4:7], s60 offen offset:256 sc1
    buffer_load_short_d16_hi v67, v60, s[4:7], s60 offen offset:384 sc1
    buffer_load_short_d16_hi v68, v60, s[4:7], s60 offen offset:512 sc1
    buffer_load_short_d16_hi v69, v60, s[4:7], s60 offen offset:640 sc1
    buffer_load_short_d16_hi v70, v60, s[4:7], s60 offen offset:768 sc1
    buffer_load_short_d16_hi v71, v60, s[4:7], s60 offen offset:896 sc1
    s_cmp_eq_u32 s25, 1
    s_waitcnt vmcnt(4)
    v_max3_u32 v62, v64, v65, v66
    v_add_f32 v56, v64, v65
    v_add_f32 v57, v66, v67
    v_add_f32 v56, v56, v1
    s_waitcnt vmcnt(0)
    v_add_f32 v58, v68, v69
    v_add_f32 v59, v70, v71
    v_add_f32 v56, v56, v57
    v_add_f32 v58, v58, v59
    v_max3_u32 v62, v62, v67, v68
    v_add_f32 v56, v56, v58
    v_max3_u32 v62, v62, v69, v70
    v_max_u32 v62, v62, v71
    v_mov_b32_dpp v58, v56 quad_perm:[1,0,3,2] row_mask:0xf bank_mask:0xf
    v_cmp_le_u32 vcc, 0xffff0000, v62
    v_cvt_pk_bf16_f32 v57, v56, v58
    s_cbranch_vccnz L_retry_g1
    v_min_u32 v57, -2, v57
    s_mov_b64 exec, s[68:69]
    s_cbranch_scc0 L_slow_g1
    buffer_store_dword v57, v61, s[4:7], s61 offen
L_sd_g1:
    s_mov_b64 exec, -1
    v_cvt_pk_bf16_f32 v1, v56, v56
    v_lshlrev_b32 v1, 16, v1
    s_add_u32 s75, s75, 0x20000
    s_branch L_bx1a
L_bx1:
    v_lshrrev_b32 v31, 2, v90
    v_lshl_add_u32 v31, v91, 3, v31
    v_lshlrev_b32 v31, 4, v31
    v_and_b32 v30, 1, v90
    v_lshl_add_u32 v31, v30, 3, v31
    v_bfe_u32 v30, v90, 1, 1
    v_lshl_add_u32 v31, v30, 11, v31
    s_lshl_b32 s60, s3, 12
    s_add_u32 s60, s60, 131072
    v_add_u32 v31, s60, v31
    ds_read_b64_tr_b16 v[74:75], v31 offset:0
    ds_read_b64_tr_b16 v[76:77], v31 offset:64
    ds_read_b64_tr_b16 v[78:79], v31 offset:512
    ds_read_b64_tr_b16 v[80:81], v31 offset:576
    ds_read_b64_tr_b16 v[82:83], v31 offset:1024
    ds_read_b64_tr_b16 v[84:85], v31 offset:1088
    ds_read_b64_tr_b16 v[86:87], v31 offset:1536
    ds_read_b64_tr_b16 v[88:89], v31 offset:1600
    v_lshlrev_b32 v31, 4, v91
    v_lshl_add_u32 v31, v90, 1, v31
    s_lshl_b32 s50, s21, 6
    s_add_u32 s50, s50, s65
    v_and_b32 v63, 3, v90
    v_lshlrev_b32 v63, 4, v63
    v_lshl_add_u32 v63, v91, 6, v63
    s_lshl_b32 s78, s3, 10
    s_add_u32 s78, s78, s64
    v_mov_b32 v10, 0x3f803f80
    v_mov_b32 v11, 0x3f803f80
    v_mov_b32 v12, 0x3f803f80
    v_mov_b32 v13, 0x3f803f80
    v_mov_b32 v14, 0x3f803f80
    v_mov_b32 v15, 0x3f803f80
    v_mov_b32 v16, 0x3f803f80
    v_mov_b32 v17, 0x3f803f80
    v_mov_b32 v18, 0x3f803f80
    v_mov_b32 v19, 0x3f803f80
    v_mov_b32 v20, 0x3f803f80
    v_mov_b32 v21, 0x3f803f80
    v_mov_b32 v22, 0x3f803f80
    v_mov_b32 v23, 0x3f803f80
    v_mov_b32 v24, 0x3f803f80
    v_mov_b32 v25, 0x3f803f80
    s_lshl_b32 s60, s3, 10
    s_add_u32 s60, s60, 154624
    v_add_u32 v26, s60, v92
    v_lshlrev_b32 v27, 4, v90
    v_add_u32 v28, 154880, v27
    v_lshl_add_u32 v27, v91, 2, v27
    v_add_u32 v27, 154624, v27
    v_lshlrev_b32 v29, 2, v91
    v_lshl_add_u32 v30, v91, 4, v29
    v_add_u32 v29, 155200, v29
    v_add_u32 v30, 155136, v30
L_bx1a:
    s_cmp_ge_u32 s21, 28
    s_cbranch_scc1 L_nogu
    s_waitcnt lgkmcnt(0)
    s_barrier
    s_branch L_poll_gu
L_retry_gu:
    s_add_u32 s27, s27, 1
    s_cmp_gt_u32 s27, 400000
    s_cbranch_scc1 L_abort
L_poll_gu:
    s_mov_b64 exec, s[28:29]
    buffer_load_dwordx4 v[10:13], v63, s[4:7], s78 offen offset:0 sc1
    buffer_load_dwordx4 v[14:17], v63, s[4:7], s78 offen offset:256 sc1
    buffer_load_dwordx4 v[18:21], v63, s[4:7], s78 offen offset:512 sc1
    buffer_load_dwordx4 v[22:25], v63, s[4:7], s78 offen offset:768 sc1
    s_mov_b64 exec, -1
    s_waitcnt vmcnt(3)
    v_mfma_f32_16x16x32_bf16 v[32:35], v[10:13], v[74:77], 0
    v_max3_u32 v62, v10, v11, v12
    v_max_u32 v62, v62, v13
    v_mfma_f32_16x16x32_bf16 v[36:39], v[10:13], v[10:13], 0
    s_waitcnt vmcnt(2)
    v_mfma_f32_16x16x32_bf16 v[32:35], v[14:17], v[78:81], v[32:35]
    v_max3_u32 v62, v62, v14, v15
    v_max3_u32 v62, v62, v16, v17
    v_mfma_f32_16x16x32_bf16 v[36:39], v[14:17], v[14:17], v[36:39]
    s_waitcnt vmcnt(1)
    v_mfma_f32_16x16x32_bf16 v[32:35], v[18:21], v[82:85], v[32:35]
    v_max3_u32 v62, v62, v18, v19
    v_max3_u32 v62, v62, v20, v21
    v_mfma_f32_16x16x32_bf16 v[36:39], v[18:21], v[18:21], v[36:39]
    s_waitcnt vmcnt(0)
    v_mfma_f32_16x16x32_bf16 v[32:35], v[22:25], v[86:89], v[32:35]
    v_max3_u32 v62, v62, v22, v23
    v_max3_u32 v62, v62, v24, v25
    v_mfma_f32_16x16x32_bf16 v[36:39], v[22:25], v[22:25], v[36:39]
    v_cmp_eq_u32 vcc, -1, v62
    s_cbranch_vccnz L_retry_gu
    s_add_u32 s64, s64, 0x1000
    s_cmp_eq_u32 s3, 0
    s_nop 3
    v_permlane32_swap_b32 v32, v36
    v_permlane32_swap_b32 v33, v37
    v_permlane32_swap_b32 v34, v38
    v_permlane32_swap_b32 v35, v39
    ds_write_b128 v26, v[32:35]
    s_waitcnt lgkmcnt(0)
    s_barrier
    s_cbranch_scc0 L_bx2
    s_cmp_eq_u32 s25, 1
    ds_read2st64_b32 v[44:45], v29 offset0:0 offset1:4
    ds_read2st64_b32 v[46:47], v29 offset0:8 offset1:12
    ds_read2st64_b32 v[48:49], v30 offset0:0 offset1:4
    ds_read2st64_b32 v[50:51], v30 offset0:8 offset1:12
    ds_read2st64_b32 v[52:53], v28 offset0:0 offset1:4
    ds_read2st64_b32 v[54:55], v28 offset0:8 offset1:12
    ds_read2st64_b32 v[40:41], v27 offset0:0 offset1:4
    ds_read2st64_b32 v[42:43], v27 offset0:8 offset1:12
    v_mov_b32 v56, s74
    s_waitcnt lgkmcnt(6)
    v_add_f32 v44, v44, v45
    v_add_f32 v46, v46, v47
    s_waitcnt lgkmcnt(4)
    v_add_f32 v48, v48, v49
    v_add_f32 v50, v50, v51
    v_add_f32 v44, v44, v46
    v_add_f32 v48, v48, v50
    v_mul_f32 v44, s73, v44
    v_fmac_f32 v56, s73, v48
    v_fma_f32 v56, -v44, v44, v56
    v_max_f32 v56, s74, v56
    v_rsq_f32 v56, v56
    s_waitcnt lgkmcnt(2)
    v_add_f32 v52, v52, v53
    v_add_f32 v54, v54, v55
    s_waitcnt lgkmcnt(0)
    v_add_f32 v40, v40, v41
    v_add_f32 v42, v42, v43
    v_add_f32 v52, v52, v54
    v_add_f32 v40, v40, v42
    v_fma_f32 v40, -v44, v52, v40
    v_mul_f32 v40, v40, v56
    s_nop 1
    v_mov_b32_dpp v41, v40 row_shl:8 row_mask:0xf bank_mask:0xf
    v_max_f32 v40, 0, v40
    v_mul_f32 v40, v40, v41
    s_nop 1
    v_mov_b32_dpp v42, v40 quad_perm:[1,0,3,2] row_mask:0xf bank_mask:0xf
    v_cvt_pk_bf16_f32 v41, v40, v42
    v_min_u32 v41, -2, v41
    s_mov_b64 exec, s[70:71]
    s_cbranch_scc0 L_slow_h
    buffer_store_dword v41, v31, s[4:7], s50 offen
L_sd_h:
    s_mov_b64 exec, -1
    s_branch L_down
L_nogu:
    s_barrier
    s_add_u32 s64, s64, 0x1000
    s_cmp_eq_u32 s3, 0
    s_cbranch_scc0 L_bx2
    s_cmp_eq_u32 s26, 0
    s_cbranch_scc0 L_noprobe
    s_lshl_b32 s60, s21, 7
    s_and_b32 s61, s21, 1
    s_lshl_b32 s61, s61, 13
    s_add_u32 s60, s60, s61
    s_add_u32 s60, s60, 458752
    s_mov_b64 exec, 1
    s_waitcnt vmcnt(0)
    s_memtime s[8:9]
    s_waitcnt lgkmcnt(0)
    buffer_load_dword v63, off, s[4:7], s60 sc1
    s_waitcnt vmcnt(0)
    s_memtime s[10:11]
    s_waitcnt lgkmcnt(0)
    s_sub_u32 s10, s10, s8
    v_mov_b32 v61, s10
    s_lshl_b32 s60, s21, 6
    s_add_u32 s60, s60, s65
    s_cmp_eq_u32 s25, 1
    s_cbranch_scc0 L_slow_prb
    buffer_store_dword v61, off, s[4:7], s60
L_sd_prb:
    s_mov_b64 exec, -1
L_noprobe:
L_down:
    v_lshrrev_b32 v2, 2, v90
    v_lshl_add_u32 v2, v91, 3, v2
    v_lshlrev_b32 v2, 5, v2
    v_and_b32 v3, 3, v90
    v_lshl_add_u32 v2, v3, 3, v2
    v_add_u32 v2, 147456, v2
    ds_read_b64_tr_b16 v[40:41], v2 offset:0
    ds_read_b64_tr_b16 v[42:43], v2 offset:128
    ds_read_b64_tr_b16 v[44:45], v2 offset:1024
    ds_read_b64_tr_b16 v[46:47], v2 offset:1152
    ds_read_b64_tr_b16 v[48:49], v2 offset:2048
    ds_read_b64_tr_b16 v[50:51], v2 offset:2176
    ds_read_b64_tr_b16 v[52:53], v2 offset:3072
    ds_read_b64_tr_b16 v[54:55], v2 offset:3200
    ds_read_b64_tr_b16 v[56:57], v2 offset:4096
    ds_read_b64_tr_b16 v[58:59], v2 offset:4224
    ds_read_b64_tr_b16 v[60:61], v2 offset:5120
    ds_read_b64_tr_b16 v[62:63], v2 offset:5248
    ds_read_b64_tr_b16 v[64:65], v2 offset:6144
    ds_read_b64_tr_b16 v[66:67], v2 offset:6272
    v_and_b32 v3, 3, v90
    v_lshlrev_b32 v3, 4, v3
    v_lshl_add_u32 v3, v91, 6, v3
    v_lshlrev_b32 v7, 3, v90
    v_lshl_add_u32 v6, v91, 13, v7
    v_lshlrev_b32 v7, 3, v90
    v_and_b32 v9, 1, v91
    v_lshl_add_u32 v7, v9, 10, v7
    v_lshrrev_b32 v9, 1, v91
    v_lshl_add_u32 v7, v9, 13, v7
    s_xor_b32 s60, s21, 16
    s_lshr_b32 s61, s60, 3
    s_lshl_b32 s61, s61, 14
    s_and_b32 s60, s60, 7
    s_lshl_b32 s60, s60, 10
    s_add_u32 s60, s60, s61
    s_lshl_b32 s61, s20, 7
    s_add_u32 s60, s60, s61
    s_add_u32 s50, s60, 393216
    s_sleep 1
    v_and_b32 v73, 3, v0
    v_lshlrev_b32 v73, 6, v73
    s_branch L_poll_dn
L_retry_dn:
    s_add_u32 s27, s27, 1
    s_cmp_gt_u32 s27, 400000
    s_cbranch_scc1 L_abort
L_poll_dn:
    buffer_load_dword v72, v73, s[4:7], s65 offen offset:1792 sc1
    buffer_load_dwordx4 v[10:13], v3, s[4:7], s65 offen offset:0 sc1
    buffer_load_dwordx4 v[14:17], v3, s[4:7], s65 offen offset:256 sc1
    buffer_load_dwordx4 v[18:21], v3, s[4:7], s65 offen offset:512 sc1
    buffer_load_dwordx4 v[22:25], v3, s[4:7], s65 offen offset:768 sc1
    buffer_load_dwordx4 v[26:29], v3, s[4:7], s65 offen offset:1024 sc1
    buffer_load_dwordx4 v[30:33], v3, s[4:7], s65 offen offset:1280 sc1
    buffer_load_dwordx4 v[34:37], v3, s[4:7], s65 offen offset:1536 sc1
    s_waitcnt lgkmcnt(0)
    s_waitcnt vmcnt(6)
    v_mfma_f32_16x16x32_bf16 v[68:71], v[10:13], v[40:43], 0
    v_max3_u32 v8, v10, v11, v12
    v_max_u32 v8, v8, v13
    s_waitcnt vmcnt(5)
    v_mfma_f32_16x16x32_bf16 v[68:71], v[14:17], v[44:47], v[68:71]
    v_max3_u32 v8, v8, v14, v15
    v_max3_u32 v8, v8, v16, v17
    s_waitcnt vmcnt(4)
    v_mfma_f32_16x16x32_bf16 v[68:71], v[18:21], v[48:51], v[68:71]
    v_max3_u32 v8, v8, v18, v19
    v_max3_u32 v8, v8, v20, v21
    s_waitcnt vmcnt(3)
    v_mfma_f32_16x16x32_bf16 v[68:71], v[22:25], v[52:55], v[68:71]
    v_max3_u32 v8, v8, v22, v23
    v_max3_u32 v8, v8, v24, v25
    s_waitcnt vmcnt(2)
    v_mfma_f32_16x16x32_bf16 v[68:71], v[26:29], v[56:59], v[68:71]
    v_max3_u32 v8, v8, v26, v27
    v_max3_u32 v8, v8, v28, v29
    s_waitcnt vmcnt(1)
    v_mfma_f32_16x16x32_bf16 v[68:71], v[30:33], v[60:63], v[68:71]
    v_max3_u32 v8, v8, v30, v31
    v_max3_u32 v8, v8, v32, v33
    s_waitcnt vmcnt(0)
    v_mfma_f32_16x16x32_bf16 v[68:71], v[34:37], v[64:67], v[68:71]
    v_max3_u32 v8, v8, v34, v35
    v_max3_u32 v8, v8, v36, v37
    s_cmp_eq_u32 s26, 1
    v_cmp_eq_u32 vcc, -1, v8
    s_cbranch_vccnz L_retry_dn
    s_nop 2
    v_cvt_pk_bf16_f32 v68, v68, v69
    v_cvt_pk_bf16_f32 v69, v70, v71
    v_pk_min_u16 v68, v68, -2 op_sel_hi:[1,0]
    v_pk_min_u16 v69, v69, -2 op_sel_hi:[1,0]
    s_cbranch_scc1 L_last
    buffer_store_dwordx2 v[68:69], v7, s[4:7], s48 offen sc1
    v_readlane_b32 s60, v72, 0
    v_readlane_b32 s61, v72, 1
    v_readlane_b32 s100, v72, 2
    v_readlane_b32 s101, v72, 3
    s_min_u32 s60, s60, s100
    s_min_u32 s61, s61, s101
    s_max_u32 s78, s60, s61
    s_and_b32 s100, s0, 3
    s_or_b32 s101, s100, 4
    s_cmp_lt_u32 s60, s61
    s_cselect_b32 s100, s100, s101
    s_cmp_eq_u32 s78, -1
    s_cselect_b32 s49, s49, s100
    v_lshlrev_b32 v60, 3, v90
    v_lshl_add_u32 v60, v91, 1, v60
    v_mov_b32 v64, 0
    v_mov_b32 v65, 0
    v_mov_b32 v66, 0
    v_mov_b32 v67, 0
    v_mov_b32 v68, 0
    v_mov_b32 v69, 0
    v_mov_b32 v70, 0
    v_mov_b32 v71, 0
    v_lshrrev_b32 v61, 3, v90
    v_lshlrev_b32 v61, 6, v61
    v_lshl_add_u32 v61, v91, 4, v61
    v_and_b32 v59, 7, v90
    v_lshl_add_u32 v61, v59, 1, v61
    v_lshrrev_b32 v2, 2, v90
    v_lshl_add_u32 v2, v91, 2, v2
    v_and_b32 v3, 7, v2
    v_lshrrev_b32 v2, 3, v2
    v_lshlrev_b32 v2, 11, v2
    v_lshl_add_u32 v2, v3, 5, v2
    v_and_b32 v9, 3, v90
    v_lshl_add_u32 v2, v9, 3, v2
    v_add_u32 v2, s79, v2
    v_lshlrev_b32 v8, 4, v9
    v_add_u32 v8, 163072, v8
    s_lshl_b32 s60, s3, 2
    v_add_u32 v3, s60, v8
    v_mov_b32 v4, 0x40000
    v_cmp_gt_u32 vcc, 4, v0
    s_nop 1
    v_cndmask_b32 v3, v4, v3, vcc
    s_mul_i32 s60, s3, 2112
    s_add_u32 s60, s60, 154624
    v_mul_u32_u24 v4, 528, v9
    v_lshrrev_b32 v5, 2, v90
    v_lshl_add_u32 v4, v5, 6, v4
    v_lshl_add_u32 v4, v91, 4, v4
    v_add_u32 v4, s60, v4
    s_mul_i32 s60, s3, 528
    s_add_u32 s60, s60, 154624
    v_lshlrev_b32 v5, 3, v0
    v_add_u32 v5, s60, v5
    s_lshl_b32 s60, s3, 4
    s_add_u32 s60, s60, 163072
    v_mov_b32 v6, s60
    v_lshlrev_b32 v7, 10, v91
    v_bfe_u32 v86, v0, 2, 2
    v_lshl_add_u32 v7, v86, 8, v7
    v_lshl_add_u32 v7, v9, 2, v7
    v_and_b32 v86, 3, v90
    v_lshlrev_b32 v86, 4, v86
    v_lshl_add_u32 v86, v91, 6, v86
    v_lshrrev_b32 v31, 3, v90
    v_lshlrev_b32 v31, 6, v31
    v_lshl_add_u32 v31, v91, 10, v31
    v_and_b32 v30, 7, v90
    v_lshl_add_u32 v31, v30, 1, v31
    s_add_u32 s50, s24, 67584
    s_lshl_b32 s60, s23, 7
    s_xor_b32 s61, s22, 2
    s_lshl_b32 s61, s61, 4
    s_add_u32 s60, s60, s61
    s_add_u32 s60, s60, s50
    s_mov_b32 s50, s60
    s_add_u32 s36, s36, 0x8000
    s_add_u32 s37, s37, 0x400
    s_add_u32 s66, s66, 0x40000
    s_lshl_b32 s67, s22, 10
    s_add_u32 s67, s67, s24
    s_add_u32 s67, s67, 67584
    s_mov_b32 s26, 1
    s_add_u32 s62, s62, 0x8000
    s_add_u32 s63, s63, 0x400
    s_add_u32 s65, s65, 0x800
    v_and_b32 v63, 3, v90
    v_lshlrev_b32 v63, 4, v63
    v_lshl_add_u32 v63, v91, 6, v63
    s_lshl_b32 s78, s3, 10
    s_add_u32 s78, s78, s64
    v_mov_b32 v10, 0x3f803f80
    v_mov_b32 v11, 0x3f803f80
    v_mov_b32 v12, 0x3f803f80
    v_mov_b32 v13, 0x3f803f80
    v_mov_b32 v14, 0x3f803f80
    v_mov_b32 v15, 0x3f803f80
    v_mov_b32 v16, 0x3f803f80
    v_mov_b32 v17, 0x3f803f80
    v_mov_b32 v18, 0x3f803f80
    v_mov_b32 v19, 0x3f803f80
    v_mov_b32 v20, 0x3f803f80
    v_mov_b32 v21, 0x3f803f80
    v_mov_b32 v22, 0x3f803f80
    v_mov_b32 v23, 0x3f803f80
    v_mov_b32 v24, 0x3f803f80
    v_mov_b32 v25, 0x3f803f80
    s_lshl_b32 s60, s3, 10
    s_add_u32 s60, s60, 154624
    v_add_u32 v26, s60, v92
    v_lshlrev_b32 v27, 4, v90
    v_add_u32 v28, 154880, v27
    v_lshl_add_u32 v27, v91, 2, v27
    v_add_u32 v27, 154624, v27
    v_lshlrev_b32 v29, 2, v91
    v_lshl_add_u32 v30, v91, 4, v29
    v_add_u32 v29, 155200, v29
    v_add_u32 v30, 155136, v30
    s_lshl_b32 s61, s21, 7
    s_add_u32 s61, s61, s64
    s_sleep 3
    s_and_b32 s60, s49, 1
    s_lshl_b32 s60, s60, 10
    s_lshr_b32 s100, s49, 2
    s_lshl_b32 s100, s100, 13
    s_add_u32 s60, s60, s100
    s_add_u32 s60, s60, s75
    s_branch L_poll_g2
L_retry_g2:
    s_add_u32 s27, s27, 1
    s_cmp_gt_u32 s27, 400000
    s_cbranch_scc1 L_abort
L_poll_g2:
    buffer_load_short_d16_hi v64, v60, s[4:7], s60 offen offset:0 sc1
    buffer_load_short_d16_hi v65, v60, s[4:7], s60 offen offset:128 sc1
    buffer_load_short_d16_hi v66, v60, s[4:7], s60 offen offset:256 sc1
    buffer_load_short_d16_hi v67, v60, s[4:7], s60 offen offset:384 sc1
    buffer_load_short_d16_hi v68, v60, s[4:7], s60 offen offset:512 sc1
    buffer_load_short_d16_hi v69, v60, s[4:7], s60 offen offset:640 sc1
    buffer_load_short_d16_hi v70, v60, s[4:7], s60 offen offset:768 sc1
    buffer_load_short_d16_hi v71, v60, s[4:7], s60 offen offset:896 sc1
    s_cmp_eq_u32 s25, 1
    s_waitcnt vmcnt(4)
    v_max3_u32 v62, v64, v65, v66
    v_add_f32 v56, v64, v65
    v_add_f32 v57, v66, v67
    v_add_f32 v56, v56, v1
    s_waitcnt vmcnt(0)
    v_add_f32 v58, v68, v69
    v_add_f32 v59, v70, v71
    v_add_f32 v56, v56, v57
    v_add_f32 v58, v58, v59
    v_max3_u32 v62, v62, v67, v68
    v_add_f32 v56, v56, v58
    v_max3_u32 v62, v62, v69, v70
    v_max_u32 v62, v62, v71
    v_mov_b32_dpp v58, v56 quad_perm:[1,0,3,2] row_mask:0xf bank_mask:0xf
    v_cmp_le_u32 vcc, 0xffff0000, v62
    v_cvt_pk_bf16_f32 v57, v56, v58
    s_cbranch_vccnz L_retry_g2
    v_min_u32 v57, -2, v57
    s_mov_b64 exec, s[68:69]
    s_cbranch_scc0 L_slow_g2
    buffer_store_dword v57, v61, s[4:7], s61 offen
L_sd_g2:
    s_mov_b64 exec, -1
    v_cvt_pk_bf16_f32 v1, v56, v56
    v_lshlrev_b32 v1, 16, v1
    s_add_u32 s75, s75, 0x20000
    s_branch L_bx2a
L_bx2:
    s_cmp_eq_u32 s26, 1
    s_cbranch_scc1 L_fin
    v_lshrrev_b32 v2, 2, v90
    v_lshl_add_u32 v2, v91, 2, v2
    v_and_b32 v3, 7, v2
    v_lshrrev_b32 v2, 3, v2
    v_lshlrev_b32 v2, 11, v2
    v_lshl_add_u32 v2, v3, 5, v2
    v_and_b32 v9, 3, v90
    v_lshl_add_u32 v2, v9, 3, v2
    v_add_u32 v2, s79, v2
    v_lshlrev_b32 v8, 4, v9
    v_add_u32 v8, 163072, v8
    s_lshl_b32 s60, s3, 2
    v_add_u32 v3, s60, v8
    v_mov_b32 v4, 0x40000
    v_cmp_gt_u32 vcc, 4, v0
    s_nop 1
    v_cndmask_b32 v3, v4, v3, vcc
    s_mul_i32 s60, s3, 2112
    s_add_u32 s60, s60, 154624
    v_mul_u32_u24 v4, 528, v9
    v_lshrrev_b32 v5, 2, v90
    v_lshl_add_u32 v4, v5, 6, v4
    v_lshl_add_u32 v4, v91, 4, v4
    v_add_u32 v4, s60, v4
    s_mul_i32 s60, s3, 528
    s_add_u32 s60, s60, 154624
    v_lshlrev_b32 v5, 3, v0
    v_add_u32 v5, s60, v5
    s_lshl_b32 s60, s3, 4
    s_add_u32 s60, s60, 163072
    v_mov_b32 v6, s60
    v_lshlrev_b32 v7, 10, v91
    v_bfe_u32 v86, v0, 2, 2
    v_lshl_add_u32 v7, v86, 8, v7
    v_lshl_add_u32 v7, v9, 2, v7
    v_and_b32 v86, 3, v90
    v_lshlrev_b32 v86, 4, v86
    v_lshl_add_u32 v86, v91, 6, v86
    v_lshrrev_b32 v31, 3, v90
    v_lshlrev_b32 v31, 6, v31
    v_lshl_add_u32 v31, v91, 10, v31
    v_and_b32 v30, 7, v90
    v_lshl_add_u32 v31, v30, 1, v31
    s_add_u32 s50, s24, 67584
    s_lshl_b32 s60, s23, 7
    s_xor_b32 s61, s22, 2
    s_lshl_b32 s61, s61, 4
    s_add_u32 s60, s60, s61
    s_add_u32 s60, s60, s50
    s_mov_b32 s50, s60
    s_add_u32 s36, s36, 0x8000
    s_add_u32 s37, s37, 0x400
    s_add_u32 s66, s66, 0x40000
    s_lshl_b32 s67, s22, 10
    s_add_u32 s67, s67, s24
    s_add_u32 s67, s67, 67584
    s_mov_b32 s26, 1
    s_add_u32 s62, s62, 0x8000
    s_add_u32 s63, s63, 0x400
    s_add_u32 s65, s65, 0x800
    v_and_b32 v63, 3, v90
    v_lshlrev_b32 v63, 4, v63
    v_lshl_add_u32 v63, v91, 6, v63
    s_lshl_b32 s78, s3, 10
    s_add_u32 s78, s78, s64
    v_mov_b32 v10, 0x3f803f80
    v_mov_b32 v11, 0x3f803f80
    v_mov_b32 v12, 0x3f803f80
    v_mov_b32 v13, 0x3f803f80
    v_mov_b32 v14, 0x3f803f80
    v_mov_b32 v15, 0x3f803f80
    v_mov_b32 v16, 0x3f803f80
    v_mov_b32 v17, 0x3f803f80
    v_mov_b32 v18, 0x3f803f80
    v_mov_b32 v19, 0x3f803f80
    v_mov_b32 v20, 0x3f803f80
    v_mov_b32 v21, 0x3f803f80
    v_mov_b32 v22, 0x3f803f80
    v_mov_b32 v23, 0x3f803f80
    v_mov_b32 v24, 0x3f803f80
    v_mov_b32 v25, 0x3f803f80
    s_lshl_b32 s60, s3, 10
    s_add_u32 s60, s60, 154624
    v_add_u32 v26, s60, v92
    v_lshlrev_b32 v27, 4, v90
    v_add_u32 v28, 154880, v27
    v_lshl_add_u32 v27, v91, 2, v27
    v_add_u32 v27, 154624, v27
    v_lshlrev_b32 v29, 2, v91
    v_lshl_add_u32 v30, v91, 4, v29
    v_add_u32 v29, 155200, v29
    v_add_u32 v30, 155136, v30
L_bx2a:
    s_waitcnt lgkmcnt(0)
    s_barrier
    s_branch L_poll_wq
L_retry_wq:
    s_add_u32 s27, s27, 1
    s_cmp_gt_u32 s27, 400000
    s_cbranch_scc1 L_abort
L_poll_wq:
    s_mov_b64 exec, s[28:29]
    buffer_load_dwordx4 v[10:13], v63, s[4:7], s78 offen offset:0 sc1
    buffer_load_dwordx4 v[14:17], v63, s[4:7], s78 offen offset:256 sc1
    buffer_load_dwordx4 v[18:21], v63, s[4:7], s78 offen offset:512 sc1
    buffer_load_dwordx4 v[22:25], v63, s[4:7], s78 offen offset:768 sc1
    s_mov_b64 exec, -1
    s_waitcnt vmcnt(3)
    v_mfma_f32_16x16x32_bf16 v[32:35], v[10:13], v[96:99], 0
    v_max3_u32 v62, v10, v11, v12
    v_max_u32 v62, v62, v13
    v_mfma_f32_16x16x32_bf16 v[36:39], v[10:13], v[10:13], 0
    s_waitcnt vmcnt(2)
    v_mfma_f32_16x16x32_bf16 v[32:35], v[14:17], v[100:103], v[32:35]
    v_max3_u32 v62, v62, v14, v15
    v_max3_u32 v62, v62, v16, v17
    v_mfma_f32_16x16x32_bf16 v[36:39], v[14:17], v[14:17], v[36:39]
    s_waitcnt vmcnt(1)
    v_mfma_f32_16x16x32_bf16 v[32:35], v[18:21], v[104:107], v[32:35]
    v_max3_u32 v62, v62, v18, v19
    v_max3_u32 v62, v62, v20, v21
    v_mfma_f32_16x16x32_bf16 v[36:39], v[18:21], v[18:21], v[36:39]
    s_waitcnt vmcnt(0)
    v_mfma_f32_16x16x32_bf16 v[32:35], v[22:25], v[108:111], v[32:35]
    v_max3_u32 v62, v62, v22, v23
    v_max3_u32 v62, v62, v24, v25
    v_mfma_f32_16x16x32_bf16 v[36:39], v[22:25], v[22:25], v[36:39]
    v_cmp_eq_u32 vcc, -1, v62
    s_cbranch_vccnz L_retry_wq
    s_add_u32 s64, s64, 0x1000
    s_cmp_eq_u32 s3, 0
    s_nop 3
    v_permlane32_swap_b32 v32, v36
    v_permlane32_swap_b32 v33, v37
    v_permlane32_swap_b32 v34, v38
    v_permlane32_swap_b32 v35, v39
    ds_write_b128 v26, v[32:35]
    s_waitcnt lgkmcnt(0)
    s_barrier
    s_cbranch_scc0 L_q2w
    s_cmp_eq_u32 s25, 1
    ds_read2st64_b32 v[44:45], v29 offset0:0 offset1:4
    ds_read2st64_b32 v[46:47], v29 offset0:8 offset1:12
    ds_read2st64_b32 v[48:49], v30 offset0:0 offset1:4
    ds_read2st64_b32 v[50:51], v30 offset0:8 offset1:12
    ds_read2st64_b32 v[52:53], v28 offset0:0 offset1:4
    ds_read2st64_b32 v[54:55], v28 offset0:8 offset1:12
    ds_read2st64_b32 v[40:41], v27 offset0:0 offset1:4
    ds_read2st64_b32 v[42:43], v27 offset0:8 offset1:12
    v_mov_b32 v56, s74
    s_waitcnt lgkmcnt(6)
    v_add_f32 v44, v44, v45
    v_add_f32 v46, v46, v47
    s_waitcnt lgkmcnt(4)
    v_add_f32 v48, v48, v49
    v_add_f32 v50, v50, v51
    v_add_f32 v44, v44, v46
    v_add_f32 v48, v48, v50
    v_mul_f32 v44, s73, v44
    v_fmac_f32 v56, s73, v48
    v_fma_f32 v56, -v44, v44, v56
    v_max_f32 v56, s74, v56
    v_rsq_f32 v56, v56
    s_waitcnt lgkmcnt(2)
    v_add_f32 v52, v52, v53
    v_add_f32 v54, v54, v55
    s_waitcnt lgkmcnt(0)
    v_add_f32 v40, v40, v41
    v_add_f32 v42, v42, v43
    v_add_f32 v52, v52, v54
    v_add_f32 v40, v40, v42
    v_fma_f32 v40, -v44, v52, v40
    v_mul_f32 v40, v40, v56
    s_nop 1
    v_mov_b32_dpp v42, v40 quad_perm:[1,0,3,2] row_mask:0xf bank_mask:0xf
    v_cvt_pk_bf16_f32 v41, v40, v42
    v_min_u32 v41, -2, v41
    s_mov_b64 exec, s[68:69]
    s_cbranch_scc0 L_slow_q
    buffer_store_dword v41, v31, s[4:7], s50 offen
L_sd_q:
    s_mov_b64 exec, -1
L_q2w:
    s_barrier
    s_sleep 2
    s_branch L_poll_q2
L_retry_q2:
    s_add_u32 s27, s27, 1
    s_cmp_gt_u32 s27, 400000
    s_cbranch_scc1 L_abort
L_poll_q2:
    buffer_load_dwordx4 v[10:13], v86, s[4:7], s67 offen offset:0 sc1
    buffer_load_dwordx4 v[14:17], v86, s[4:7], s67 offen offset:256 sc1
    buffer_load_dwordx4 v[18:21], v86, s[4:7], s67 offen offset:512 sc1
    buffer_load_dwordx4 v[22:25], v86, s[4:7], s67 offen offset:768 sc1
    s_waitcnt vmcnt(0)
    s_branch L_att
L_last:
    s_mov_b32 exec_hi, 0
    buffer_store_dwordx2 v[68:69], v6, s[4:7], s50 offen sc1
    s_mov_b32 exec_hi, -1
    s_lshr_b32 s60, s21, 3
    s_lshl_b32 s60, s60, 14
    s_and_b32 s61, s21, 7
    s_lshl_b32 s61, s61, 10
    s_add_u32 s75, s60, s61
    s_lshr_b32 s60, s49, 2
    s_lshl_b32 s60, s60, 13
    s_add_u32 s75, s75, s60
    s_add_u32 s75, s75, 393216
    s_and_b32 s60, s21, 7
    s_cmp_eq_u32 s60, s20
    s_cbranch_scc0 L_fin
    v_lshlrev_b32 v60, 3, v90
    v_lshl_add_u32 v60, v91, 1, v60
    v_mov_b32 v64, 0
    v_mov_b32 v65, 0
    v_mov_b32 v66, 0
    v_mov_b32 v67, 0
    v_mov_b32 v68, 0
    v_mov_b32 v69, 0
    v_mov_b32 v70, 0
    v_mov_b32 v71, 0
    v_lshlrev_b32 v61, 10, v91
    v_lshl_add_u32 v61, v90, 1, v61
    s_mov_b32 s80, s54
    s_and_b32 s81, s55, 0xffff
    s_mov_b32 s82, 4096
    s_mov_b32 s83, 0x20000
    s_lshl_b32 s61, s21, 5
    s_sleep 7
    s_branch L_poll_g4
L_retry_g4:
    s_add_u32 s27, s27, 1
    s_cmp_gt_u32 s27, 400000
    s_cbranch_scc1 L_abort
L_poll_g4:
    buffer_load_short_d16_hi v64, v60, s[4:7], s75 offen offset:0 sc1
    buffer_load_short_d16_hi v65, v60, s[4:7], s75 offen offset:128 sc1
    buffer_load_short_d16_hi v66, v60, s[4:7], s75 offen offset:256 sc1
    buffer_load_short_d16_hi v67, v60, s[4:7], s75 offen offset:384 sc1
    buffer_load_short_d16_hi v68, v60, s[4:7], s75 offen offset:512 sc1
    buffer_load_short_d16_hi v69, v60, s[4:7], s75 offen offset:640 sc1
    buffer_load_short_d16_hi v70, v60, s[4:7], s75 offen offset:768 sc1
    buffer_load_short_d16_hi v71, v60, s[4:7], s75 offen offset:896 sc1
    s_waitcnt vmcnt(4)
    v_max3_u32 v62, v64, v65, v66
    v_add_f32 v56, v64, v65
    v_add_f32 v57, v66, v67
    v_add_f32 v56, v56, v1
    s_waitcnt vmcnt(0)
    v_add_f32 v58, v68, v69
    v_add_f32 v59, v70, v71
    v_add_f32 v56, v56, v57
    v_add_f32 v58, v58, v59
    v_max3_u32 v62, v62, v67, v68
    v_add_f32 v56, v56, v58
    v_max3_u32 v62, v62, v69, v70
    v_max_u32 v62, v62, v71
    v_mov_b32_dpp v58, v56 quad_perm:[1,0,3,2] row_mask:0xf bank_mask:0xf
    v_cmp_le_u32 vcc, 0xffff0000, v62
    v_cvt_pk_bf16_f32 v57, v56, v58
    s_cbranch_vccnz L_retry_g4
    v_min_u32 v57, -2, v57
    s_mov_b64 exec, s[68:69]
    buffer_store_dword v57, v61, s[80:83], s61 offen
    s_mov_b64 exec, -1
L_fin:
L_end:
    s_endpgm
L_abort:
    s_mov_b64 exec, 1
    v_mov_b32 v2, 3669952
    v_mov_b32 v3, 1
    buffer_store_dword v3, v2, s[4:7], 0 offen
    s_endpgm
L_slow_op:
    buffer_store_dword v18, v7, s[4:7], s36 offen sc1
    s_branch L_sd_op
L_slow_st:
    buffer_store_dwordx2 v[8:9], off, s[4:7], s37 sc1
    s_branch L_sd_st
L_slow_g1:
    buffer_store_dword v57, v61, s[4:7], s61 offen sc1
    s_branch L_sd_g1
L_slow_h:
    buffer_store_dword v41, v31, s[4:7], s50 offen sc1
    s_branch L_sd_h
L_slow_prb:
    buffer_store_dword v61, off, s[4:7], s60 sc1
    s_branch L_sd_prb
L_slow_g2:
    buffer_store_dword v57, v61, s[4:7], s61 offen sc1
    s_branch L_sd_g2
L_slow_q:
    buffer_store_dword v41, v31, s[4:7], s50 offen sc1
    s_branch L_sd_q

.section .rodata,"a"
.p2align 6
.amdhsa_kernel interleave_layers__gqa_block_cached__glu_gated_reglu__decode_kernel
  .amdhsa_next_free_vgpr 512
  .amdhsa_next_free_sgpr 102
  .amdhsa_accum_offset 256
  .amdhsa_group_segment_fixed_size 0
  .amdhsa_kernarg_size 96
  .amdhsa_user_sgpr_count 2
  .amdhsa_user_sgpr_kernarg_segment_ptr 1
  .amdhsa_system_sgpr_workgroup_id_x 1
.end_amdhsa_kernel
```
